```python
import torch

def _softmax(x, axis=-1):
    return torch.softmax(x, dim=axis)
def _gelu(x):
    return torch.nn.functional.gelu(x, approximate="tanh")
def _silu(x):
    return torch.nn.functional.silu(x)
def _sigmoid(x):
    return torch.sigmoid(x)
def _layernorm(x, axis=-1, eps=1e-5):
    m = x.mean(dim=axis, keepdim=True)
    v = x.var(dim=axis, keepdim=True, unbiased=False)
    return (x - m) / torch.sqrt(v + eps)
def _scatter_add(tgt, idx, src, axis=0):
    return tgt.clone().index_add_(axis, idx, src)
def _segment_sum(src, seg, n):
    out = torch.zeros((n,) + src.shape[1:], dtype=src.dtype)
    return out.index_add_(0, seg, src)
def _pad(x, pw):
    flat = tuple(v for pair in reversed(pw) for v in pair)
    return torch.nn.functional.pad(x, flat)

kernel_name = 'standalone__sequential_behavior_din__recsys'

def setup_inputs():

    _w = (lambda a: (lambda t: t.to(torch.bfloat16) if t.is_floating_point() else t)(torch.as_tensor(a)))
    B, L, D = 4096, 20, 128
    H = D
    return {
        "target": _w((lambda *s: torch.randn(*s, dtype=torch.bfloat16) * 1.6)(B, D)),
        "hist": _w((lambda *s: torch.randn(*s, dtype=torch.bfloat16) * 1.6)(B, L, D)),
        "mask": _w((lambda lo, hi, *s: torch.randint(lo, hi, s))(0, 2, B, L).to(float)),
        "w1": _w((lambda *s: torch.randn(*s, dtype=torch.bfloat16) * 1.6)(4 * D, H) * (4 * D) ** -0.5),
        "b1": _w((lambda *s: torch.randn(*s, dtype=torch.bfloat16) * 6.4)(H) * 0.1),
        "w2": _w((lambda *s: torch.randn(*s, dtype=torch.bfloat16) * 0.05)(H, 1) * H ** -0.5),
        "b2": _w((lambda *s: torch.randn(*s, dtype=torch.bfloat16) * 0.2)(1) * 0.1),
    }

def reference(target, hist, mask, w1, b1, w2, b2):
    L = hist.shape[1]
    tgt = (lambda x, n, axis: torch.repeat_interleave(x, n, dim=axis))(target[:, None, :], L, axis=1)
    feat = torch.concatenate([hist, tgt, hist - tgt, hist * tgt], axis=-1)
    h = _sigmoid(feat @ w1 + b1)
    scores = (h @ w2 + b2)[..., 0] * mask
    return torch.einsum('bl,bld->bd', scores, hist)
```

```asm
; @launch grid=(256,1,1) block=(512,1,1) lds=163840
.amdgcn_target "amdgcn-amd-amdhsa--gfx950"
.text
.globl standalone__sequential_behavior_din__recsys_kernel
.p2align 12
.fill 832, 4, 0xbf810000
.p2align 8
.type standalone__sequential_behavior_din__recsys_kernel,@function
standalone__sequential_behavior_din__recsys_kernel:
    s_load_dwordx2 s[20:21], s[0:1], 24
    s_cmp_ge_u32 s2, 256
    s_cbranch_scc1 L_exit0
    v_readfirstlane_b32 s3, v0
    v_and_b32 v0, 63, v0
    s_lshr_b32 s3, s3, 6
    s_cmp_lt_u32 s3, 4
    s_cbranch_scc1 L_producer
    s_setprio 1
    s_sub_u32 s33, s3, 4
    s_mov_b32 s22, 131072
    s_mov_b32 s23, 0x20000
    v_lshrrev_b32 v13, 5, v0
    v_lshlrev_b32 v15, 1, v13
    v_and_b32 v14, 3, v0
    v_xor_b32 v14, v15, v14
    s_lshl_b32 s34, s33, 6
    v_lshl_add_u32 v14, v14, 4, s34
    v_lshrrev_b32 v15, 2, v0
    v_lshl_add_u32 v1, v15, 8, v14
    v_add_u32 v2, 3072, v1
    s_lshl_b32 s28, s33, 11
    s_add_u32 m0, s28, 1024
    s_lshr_b32 s26, s2, 3
    s_lshl_b32 s26, s26, 12
    s_lshl_b32 s27, s33, 10
    s_add_u32 s26, s26, s27
    s_lshr_b32 s27, s26, 3
    s_mov_b32 s26, 0x40
    v_lshlrev_b32 v15, 2, v0
    v_bfe_u32 v15, s26, v15, 4
    v_lshl_add_u32 v15, v15, 14, s27
    s_waitcnt lgkmcnt(0)
    s_mov_b64 exec, 3
    global_load_dword v220, v15, s[20:21]
    s_mov_b64 exec, -1
    buffer_load_dwordx4 v1, s[20:23], 0 offen offset:0 lds
    buffer_load_dwordx4 v2, s[20:23], 0 offen offset:1024 lds
    s_add_u32 m0, s28, 33792
    s_mov_b32 s31, 65536
    buffer_load_dwordx4 v1, s[20:23], s31 offen offset:0 lds
    buffer_load_dwordx4 v2, s[20:23], s31 offen offset:1024 lds
    s_add_u32 s44, s20, s27
    s_addc_u32 s45, s21, 0
    s_load_dword s46, s[44:45], 16384
    s_load_dword s46, s[44:45], 16448
    s_load_dword s46, s[44:45], 81920
    s_load_dword s46, s[44:45], 81984
    s_load_dword s46, s[44:45], 32768
    s_load_dword s46, s[44:45], 32832
    s_load_dword s46, s[44:45], 49152
    s_load_dword s46, s[44:45], 49216
    s_load_dword s46, s[44:45], 98304
    s_load_dword s46, s[44:45], 98368
    s_load_dword s46, s[44:45], 114688
    s_load_dword s46, s[44:45], 114752
    s_branch L_csetup
L_exit0:
    s_endpgm
L_producer:
    s_load_dwordx16 s[4:19], s[0:1], 0
    s_setprio 2
    s_getpc_b64 s[24:25]
    s_and_b32 s24, s24, 0xfffff000
    s_lshr_b32 s26, s2, 3
    s_lshl_b32 s27, s26, 9
    s_lshl_b32 s29, s3, 7
    s_add_u32 s27, s27, s29
    v_mov_b32 v6, s27
    s_lshr_b32 s27, s27, 1
    s_and_b32 s27, s27, 0x1f80
    s_bitset1_b32 s27, 14
    v_writelane_b32 v6, s27, 1
    s_mov_b64 exec, 3
    global_load_dword v21, v6, s[24:25]
    s_mov_b64 exec, -1
    s_mul_i32 s24, s2, 640
    v_lshl_add_u32 v6, v0, 4, s24
    v_and_b32 v10, 15, v0
    v_lshrrev_b32 v8, 4, v0
    v_lshlrev_b32 v7, 2, v8
    s_mov_b32 s24, 0x84c0
    v_bfe_u32 v7, s24, v7, 4
    v_xor_b32 v11, v10, v7
    v_lshlrev_b32 v11, 4, v11
    v_lshl_add_u32 v13, v8, 8, v11
    s_lshl_b32 s25, s2, 12
    s_lshl_b32 s27, s3, 10
    s_add_u32 s25, s25, s27
    v_add_u32 v7, s25, v13
    v_lshlrev_b32 v9, 2, v0
    s_mul_i32 s26, s3, 1040
    s_add_u32 s26, s26, 140288
    s_mov_b32 m0, 146752
    s_mov_b32 exec_hi, 0xff
    s_waitcnt lgkmcnt(0)
    global_load_lds_dwordx4 v6, s[8:9]
    s_mov_b32 m0, s26
    s_mov_b32 exec_hi, -1
    global_load_lds_dwordx4 v7, s[4:5]
    s_mov_b32 m0, 145984
    global_load_dword v19, v9, s[14:15]
    global_load_lds_dword v9, s[12:13]
    s_branch L_psetup
L_csetup:
    s_mov_b32 s24, 0xbfb8aa3b
    s_mov_b32 s25, 0xbfb8aa3b
    v_mov_b32 v3, 0x00003f80
    v_mov_b32 v4, 1.0
    v_mov_b32 v5, 0xffff0000
    v_mov_b32 v6, 0x4000400
    v_mov_b32 v248, 0xc11b43d5
    v_mov_b32 v249, v248
    v_mov_b32 v250, v248
    v_mov_b32 v251, v248
    v_bfe_u32 v14, v0, 2, 2
    v_and_b32 v15, 3, v0
    v_lshlrev_b32 v15, 3, v15
    v_lshl_add_u32 v14, v14, 6, v15
    s_add_u32 s34, s28, 1024
    v_add_u32 v14, s34, v14
    v_bfe_u32 v15, v0, 4, 1
    v_xor_b32 v16, v15, v13
    v_lshl_add_u32 v7, v16, 5, v14
    v_lshl_add_u32 v7, v13, 9, v7
    v_add_u32 v8, 0x10000, v7
    v_mul_u32_u24 v16, 544, v15
    v_add_u32 v14, v14, v16
    v_lshl_add_u32 v9, v13, 10, v14
    v_xor_b32 v10, 32, v9
    v_add_u32 v11, 0x10000, v9
    v_add_u32 v12, 0x10000, v10
    v_bfe_u32 v14, v0, 2, 3
    v_mul_u32_u24 v14, 1040, v14
    v_lshl_add_u32 v14, v13, 4, v14
    v_and_b32 v15, 3, v0
    v_lshl_add_u32 v21, v15, 6, v14
    v_add_u32 v21, 49920, v21
    v_lshl_add_u32 v14, v15, 8, v14
    v_lshlrev_b32 v15, 2, v15
    s_mov_b32 s34, 0x84c0
    v_bfe_u32 v15, s34, v15, 4
    v_xor_b32 v16, 0, v15
    v_lshl_add_u32 v17, v16, 4, v14
    v_xor_b32 v16, 4, v15
    v_lshl_add_u32 v18, v16, 4, v14
    v_xor_b32 v16, 8, v15
    v_lshl_add_u32 v19, v16, 4, v14
    v_xor_b32 v16, 12, v15
    v_lshl_add_u32 v20, v16, 4, v14
    v_bfe_u32 v14, v0, 2, 2
    v_mul_u32_u24 v14, 1040, v14
    v_and_b32 v16, 3, v0
    v_lshl_add_u32 v14, v16, 8, v14
    v_and_b32 v16, 48, v0
    v_add_u32 v14, v14, v16
    v_add_u32 v14, 140288, v14
    v_xor_b32 v16, 0, v15
    v_lshl_add_u32 v196, v16, 4, v14
    v_xor_b32 v16, 4, v15
    v_lshl_add_u32 v200, v16, 4, v14
    v_xor_b32 v16, 8, v15
    v_lshl_add_u32 v204, v16, 4, v14
    v_xor_b32_e64 v16, 12, v15
    v_lshl_add_u32 v208, v16, 4, v14
    s_add_u32 s34, s28, 66560
    v_lshl_add_u32 v23, v0, 4, s34
    v_lshl_add_u32 v24, v13, 8, s34
    v_and_b32 v14, 31, v0
    s_lshl_b32 s34, s33, 2
    s_add_u32 s34, s34, 74752
    v_lshl_add_u32 v22, v14, 4, s34
    v_lshlrev_b32 v26, 4, v14
    v_add_u32 v26, 146240, v26
    v_lshrrev_b32_e64 v15, 4, v0
    s_lshl_b32 s34, s33, 6
    s_add_u32 s35, s34, 145984
    v_lshl_add_u32 v15, v15, 3, s35
    s_add_u32 s34, s34, 145728
    v_lshl_add_u32 v236, v13, 3, s34
    v_and_b32_e64 v244, 16, v0
    v_lshl_add_u32 v244, v244, 1, v236
    s_mov_b32 exec_lo, 0xefeffefe
    s_mov_b32 exec_hi, 0xefeffefe
    v_mov_b32 v236, 159040
    s_mov_b64 exec, -1
    s_add_u32 m0, s28, 9216
    s_mov_b32 s31, 8192
    buffer_load_dwordx4 v1, s[20:23], s31 offen offset:0 lds
    buffer_load_dwordx4 v2, s[20:23], s31 offen offset:1024 lds
    s_add_u32 m0, s28, 41984
    s_mov_b32 s31, 73728
    buffer_load_dwordx4 v1, s[20:23], s31 offen offset:0 lds
    buffer_load_dwordx4 v2, s[20:23], s31 offen offset:1024 lds
    s_cmp_eq_u32 s33, 2
    s_cbranch_scc1 L_touchD
    s_cmp_eq_u32 s33, 3
    s_cbranch_scc1 L_touchB
    s_branch L_cons
L_psetup:
    s_mul_i32 s25, s2, 81920
    s_add_u32 s36, s6, s25
    s_addc_u32 s37, s7, 0
    s_mov_b32 s38, 81920
    s_mov_b32 s39, 0x20000
    s_setprio 0
    v_mov_b32 v232, 0
    v_mov_b32 v233, 0
    v_mov_b32 v234, 0
    v_mov_b32 v235, 0
    v_mov_b32 v236, 0
    v_mov_b32 v237, 0
    v_mov_b32 v238, 0
    v_mov_b32_e64 v239, 0
    s_mul_i32 s25, s3, 3072
    s_add_u32 s25, s25, 147776
    v_lshl_add_u32 v6, v0, 4, s25
    ds_write_b128 v6, v[232:235]
    ds_write_b128 v6, v[232:235] offset:1024
    ds_write_b128 v6, v[232:235] offset:2048
    v_and_b32 v6, 7, v0
    s_lshl_b32 s25, s3, 7
    s_add_u32 s25, s25, 146240
    v_lshl_add_u32 v6, v6, 4, s25
    ds_write_b32 v6, v232 offset:8
    v_add_u32 v37, s26, v13
    s_mul_i32 s35, s3, 2080
    s_add_u32 s50, s35, 49920
    v_add_u32 v13, s35, v13
    v_lshlrev_b32 v12, 4, v10
    v_add_u32 v12, 132096, v12
    s_lshl_b32 s25, s3, 10
    v_lshl_add_u32 v36, v8, 8, v12
    v_add_u32 v36, s25, v36
    v_lshrrev_b32 v6, 1, v10
    v_and_b32 v7, 1, v0
    v_lshl_add_u32 v30, v7, 2, v8
    v_lshl_add_u32 v30, v6, 5, v30
    s_lshl_b32 s25, s3, 3
    v_add_u32 v30, s25, v30
    v_lshlrev_b32 v22, 4, v30
    v_add_u32 v22, 74752, v22
    v_lshlrev_b32_e64 v23, 1, v30
    v_add_u32 v23, 147776, v23
    v_mul_u32_u24 v17, 544, v10
    v_lshl_add_u32 v17, v8, 4, v17
    v_add_u32 v17, 147776, v17
    v_mul_u32_u24 v18, 160, v10
    v_lshl_add_u32 v18, v8, 4, v18
    v_add_u32 v18, 156480, v18
    v_lshlrev_b32 v28, 1, v0
    v_add_u32 v28, 156480, v28
    s_lshl_b32 s26, s3, 6
    s_add_u32 s25, s26, 132096
    v_mul_u32_u24 v43, 272, v10
    v_lshl_add_u32 v43, v8, 3, v43
    v_add_u32 v43, s25, v43
    v_lshrrev_b32 v6, 2, v0
    v_and_b32 v7, 3, v0
    v_lshlrev_b32 v7, 4, v7
    v_mul_u32_u24 v44, 272, v6
    v_add3_u32 v44, v44, v7, s25
    s_lshl_b32 s25, s2, 12
    s_add_u32 s25, s25, s26
    v_lshl_add_u32 v25, v6, 8, s25
    v_add_u32 v25, v25, v7
    v_lshrrev_b32 v6, 5, v0
    v_and_b32 v7, 12, v0
    v_bfe_u32 v31, s24, v7, 4
    s_lshl_b32 s25, s3, 2
    v_xor_b32 v31, s25, v31
    v_mul_u32_u24 v14, 2080, v8
    v_lshl_add_u32 v14, v7, 6, v14
    v_lshl_add_u32 v14, v31, 4, v14
    v_and_b32 v7, 3, v0
    v_lshl_add_u32 v14, v7, 3, v14
    v_mov_b32 v38, 146752
    s_mov_b32 s22, 131072
    s_mov_b32 s23, 0x20000
    s_lshl_b32 s32, s3, 11
    v_bfe_u32 v8, v0, 3, 2
    v_lshlrev_b32 v8, 3, v8
    v_lshl_add_u32 v8, v6, 5, v8
    v_bfe_u32 v31, v0, 2, 1
    v_add_u32 v8, v8, v31
    v_lshlrev_b32 v6, 1, v6
    v_xor_b32_e64 v7, v6, v7
    v_lshl_add_u32 v7, v7, 4, s26
    v_lshl_add_u32 v8, v8, 8, v7
    v_add_u32 v45, 98304, v8
    v_add_u32 v46, 97792, v8
    v_lshlrev_b32 v39, 2, v30
    v_add_u32 v39, 144448, v39
    v_and_b32 v41, 31, v30
    v_lshlrev_b32 v41, 4, v41
    v_add_u32 v40, 146240, v41
    v_lshrrev_b32 v41, 5, v30
    v_add_u32 v41, v40, v41
    v_mov_b32 v42, 0xffff0000
    s_mov_b32 s6, 0xbfb8aa3b
    v_lshl_add_u32 v6, v0, 1, v38
    v_mov_b32 v88, v38
    v_mov_b32 v68, v38
    v_mov_b32 v89, v38
    v_mov_b32 v69, v38
    v_mov_b32 v90, v38
    v_mov_b32 v70, v38
    v_mov_b32 v91, v38
    v_mov_b32 v71, v38
    s_waitcnt vmcnt(3)
    ds_read_u16 v1, v6 offset:0
    ds_read_u16 v2, v6 offset:128
    ds_read_u16 v3, v6 offset:256
    ds_read_u16 v4, v6 offset:384
    ds_read_u16 v5, v6 offset:512
    s_waitcnt lgkmcnt(4)
    v_cmp_ne_u32 s[40:41], 0, v1
    s_waitcnt lgkmcnt(3)
    v_cmp_ne_u32 s[42:43], 0, v2
    s_waitcnt lgkmcnt(2)
    v_cmp_ne_u32 s[44:45], 0, v3
    s_waitcnt lgkmcnt(1)
    v_cmp_ne_u32 s[46:47], 0, v4
    s_waitcnt lgkmcnt(0)
    v_cmp_ne_u32 s[48:49], 0, v5
    s_bcnt1_i32_b64 s10, s[40:41]
    s_bcnt1_i32_b64 s11, s[42:43]
    s_add_u32 s11, s11, s10
    s_bcnt1_i32_b64 s28, s[44:45]
    s_add_u32 s28, s28, s11
    s_bcnt1_i32_b64 s29, s[46:47]
    s_add_u32 s29, s29, s28
    s_bcnt1_i32_b64 s31, s[48:49]
    s_add_u32 s31, s31, s29
    v_mov_b64 v[50:51], s[40:41]
    v_mov_b32 v31, v30
    v_mov_b32 v32, 0
    v_cmpx_le_u32 vcc, s10, v30
    v_mov_b64 v[50:51], s[42:43]
    v_subrev_u32 v31, s10, v30
    v_mov_b32 v32, 1
    v_cmpx_le_u32 vcc, s11, v30
    v_mov_b64 v[50:51], s[44:45]
    v_subrev_u32 v31, s11, v30
    v_mov_b32 v32, 2
    v_cmpx_le_u32 vcc, s28, v30
    v_mov_b64 v[50:51], s[46:47]
    v_subrev_u32 v31, s28, v30
    v_mov_b32 v32, 3
    v_cmpx_le_u32 vcc, s29, v30
    v_mov_b64 v[50:51], s[48:49]
    v_subrev_u32 v31, s29, v30
    v_mov_b32 v32, 4
    s_mov_b64 exec, -1
    v_bcnt_u32_b32 v6, v50, 0
    v_sub_co_u32 v6, vcc, v31, v6
    v_min_u32 v31, v31, v6
    s_nop 0
    v_cndmask_b32 v50, v51, v50, vcc
    v_addc_co_u32 v32, vcc, v32, v32, vcc
    v_and_b32 v6, 0xffff, v50
    v_bcnt_u32_b32 v6, v6, 0
    v_sub_co_u32 v6, vcc, v31, v6
    v_min_u32 v31, v31, v6
    v_lshrrev_b32 v7, 16, v50
    v_cndmask_b32 v50, v7, v50, vcc
    v_addc_co_u32 v32, vcc, v32, v32, vcc
    v_and_b32 v6, 0xff, v50
    v_bcnt_u32_b32 v6, v6, 0
    v_sub_co_u32 v6, vcc, v31, v6
    v_min_u32 v31, v31, v6
    v_lshrrev_b32 v7, 8, v50
    v_cndmask_b32 v50, v7, v50, vcc
    v_addc_co_u32 v32, vcc, v32, v32, vcc
    v_and_b32 v6, 0xf, v50
    v_bcnt_u32_b32 v6, v6, 0
    v_sub_co_u32 v6, vcc, v31, v6
    v_min_u32 v31, v31, v6
    v_lshrrev_b32 v7, 4, v50
    v_cndmask_b32 v50, v7, v50, vcc
    v_addc_co_u32 v32, vcc, v32, v32, vcc
    v_and_b32 v6, 0x3, v50
    v_bcnt_u32_b32 v6, v6, 0
    v_sub_co_u32 v6, vcc, v31, v6
    v_min_u32 v31, v31, v6
    v_lshrrev_b32 v7, 2, v50
    v_cndmask_b32 v50, v7, v50, vcc
    v_addc_co_u32 v32, vcc, v32, v32, vcc
    v_and_b32 v6, 1, v50
    v_cmp_lt_u32 vcc, v31, v6
    v_cmp_gt_u32 s[26:27], s31, v30
    v_mov_b32 v7, 0x1ff
    v_addc_co_u32 v32, vcc, v32, v32, vcc
    v_xor_b32 v32, 63, v32
    v_cndmask_b32 v32, v7, v32, s[26:27]
    v_lshlrev_b32 v33, 8, v32
    v_lshl_add_u32 v6, v32, 1, v38
    ds_read_u16 v35, v6
    s_waitcnt vmcnt(0)
    ds_read_b128 v[212:215], v37
    s_add_u32 s30, s31, 31
    s_lshr_b32 s30, s30, 5
    s_max_u32 s30, s30, 2
    s_sub_u32 s51, s30, 2
    s_cmp_le_u32 s30, 5
    s_cselect_b64 vcc, -1, 0
    v_add_u32_dpp v72, v33, v11 row_newbcast:0 row_mask:0xf bank_mask:0xf
    v_add_u32_dpp v73, v33, v11 row_newbcast:1 row_mask:0xf bank_mask:0xf
    v_add_u32_dpp v74, v33, v11 row_newbcast:2 row_mask:0xf bank_mask:0xf
    v_add_u32_dpp v75, v33, v11 row_newbcast:3 row_mask:0xf bank_mask:0xf
    v_add_u32_dpp v76, v33, v11 row_newbcast:4 row_mask:0xf bank_mask:0xf
    v_add_u32_dpp v77, v33, v11 row_newbcast:5 row_mask:0xf bank_mask:0xf
    s_waitcnt lgkmcnt(0)
    s_load_dword s33, s[16:17], 0
    v_mul_u32_u24 v34, 3277, v32
    v_bfe_u32 v34, v34, 16, 4
    v_cndmask_b32 v35, 0, v35, s[26:27]
    v_lshlrev_b32 v24, 16, v35
    v_lshl_or_b32 v35, v34, 4, v24
    v_lshlrev_b32 v34, 8, v34
    v_mov_b32 v2, s31
    v_lshlrev_b32 v172, 16, v212
    v_and_b32 v173, 0xffff0000, v212
    v_lshlrev_b32 v174, 16, v213
    v_and_b32 v175, 0xffff0000, v213
    v_lshlrev_b32 v176, 16, v214
    v_and_b32 v177, 0xffff0000, v214
    v_lshlrev_b32 v178, 16, v215
    v_and_b32 v179, 0xffff0000, v215
    v_mul_f32 v172, s6, v172
    v_mul_f32 v173, s6, v173
    v_mul_f32 v174, s6, v174
    v_mul_f32 v175, s6, v175
    v_mul_f32 v176, s6, v176
    v_mul_f32 v177, s6, v177
    v_mul_f32 v178, s6, v178
    v_mul_f32_e64 v179, s6, v179
    v_add_u32_dpp v52, v34, v12 row_newbcast:0 row_mask:0xf bank_mask:0xf
    v_add_u32_dpp v53, v34, v12 row_newbcast:1 row_mask:0xf bank_mask:0xf
    v_add_u32_dpp v54, v34, v12 row_newbcast:2 row_mask:0xf bank_mask:0xf
    v_add_u32_dpp v55, v34, v12 row_newbcast:3 row_mask:0xf bank_mask:0xf
    s_lshl_b32 s24, s51, 7
    s_add_u32 s24, s24, 144448
    v_add_u32 v26, s24, v9
    s_lshl_b32 s24, s51, 9
    s_add_u32 s24, s24, 74752
    v_lshl_add_u32 v27, v0, 4, s24
    s_cmp_ge_u32 s51, 6
    s_cselect_b32 s24, 6, 0
    s_sub_u32 s24, s51, s24
    s_mul_i32 s25, s24, 8320
    v_add_u32 v15, s25, v14
    s_add_u32 s25, s25, 8320
    s_cmp_eq_u32 s24, 5
    s_cselect_b32 s25, 0, s25
    v_add_u32 v16, s25, v14
    s_branch L_pmain
.p2align 12
L_touchB:
    s_branch L_cons
    s_nop 0
L_pmain:
    s_barrier
    s_add_u32 m0, s32, 99328
    s_movk_i32 s4, 0
    buffer_load_dwordx4 v45, s[20:23], s4 offen offset:0 lds
    buffer_load_dwordx4 v46, s[20:23], s4 offen offset:1024 lds
    s_add_u32 m0, s32, 107520
    s_movk_i32 s4, 1024
    buffer_load_dwordx4 v45, s[20:23], s4 offen offset:0 lds
    buffer_load_dwordx4 v46, s[20:23], s4 offen offset:1024 lds
    s_add_u32 m0, s35, 0
    s_nop 0
    buffer_load_dwordx4 v72, s[36:39], 0 offen nt lds
    s_add_u32 m0, s35, 1040
    s_nop 0
    buffer_load_dwordx4 v73, s[36:39], 0 offen nt lds
    s_add_u32 m0, s35, 8320
    s_nop 0
    buffer_load_dwordx4 v74, s[36:39], 0 offen nt lds
    s_add_u32 m0, s35, 9360
    s_nop 0
    buffer_load_dwordx4 v75, s[36:39], 0 offen nt lds
    s_add_u32 m0, s32, 115712
    s_movk_i32 s4, 16384
    buffer_load_dwordx4 v45, s[20:23], s4 offen offset:0 lds
    buffer_load_dwordx4 v46, s[20:23], s4 offen offset:1024 lds
    s_add_u32 m0, s32, 123904
    s_movk_i32 s4, 17408
    buffer_load_dwordx4 v45, s[20:23], s4 offen offset:0 lds
    buffer_load_dwordx4 v46, s[20:23], s4 offen offset:1024 lds
    v_lshlrev_b32 v220, 16, v19
    v_and_b32 v221, 0xffff0000, v19
    v_and_b32 v222, 0x7fffffff, v220
    v_and_b32 v223, 0x7fffffff, v221
    v_max_u32 v8, v222, v223
    v_add_u32_dpp v78, v33, v11 row_newbcast:6 row_mask:0xf bank_mask:0xf
    v_add_u32_dpp v79, v33, v11 row_newbcast:7 row_mask:0xf bank_mask:0xf
    v_max_u32_dpp v8, v8, v8 row_shr:1 row_mask:0xf bank_mask:0xf
    v_add_u32_dpp v80, v33, v11 row_newbcast:8 row_mask:0xf bank_mask:0xf
    v_add_u32_dpp v81, v33, v11 row_newbcast:9 row_mask:0xf bank_mask:0xf
    v_max_u32_dpp v8, v8, v8 row_shr:2 row_mask:0xf bank_mask:0xf
    v_add_u32_dpp v82, v33, v11 row_newbcast:10 row_mask:0xf bank_mask:0xf
    v_add_u32_dpp v83, v33, v11 row_newbcast:11 row_mask:0xf bank_mask:0xf
    v_max_u32_dpp v8, v8, v8 row_shr:4 row_mask:0xf bank_mask:0xf
    v_add_u32_dpp v56, v34, v12 row_newbcast:4 row_mask:0xf bank_mask:0xf
    v_add_u32_dpp v57, v34, v12 row_newbcast:5 row_mask:0xf bank_mask:0xf
    v_max_u32_dpp v8, v8, v8 row_shr:8 row_mask:0xf bank_mask:0xf
    v_add_u32_dpp v58, v34, v12 row_newbcast:6 row_mask:0xf bank_mask:0xf
    v_add_u32_dpp v59, v34, v12 row_newbcast:7 row_mask:0xf bank_mask:0xf
    v_max_u32_dpp v8, v8, v8 row_bcast:15 row_mask:0xa bank_mask:0xf
    v_add_u32_dpp v60, v34, v12 row_newbcast:8 row_mask:0xf bank_mask:0xf
    v_add_u32_dpp v61, v34, v12 row_newbcast:9 row_mask:0xf bank_mask:0xf
    v_max_u32_dpp v8, v8, v8 row_bcast:31 row_mask:0xc bank_mask:0xf
    v_add_u32_dpp v62, v34, v12 row_newbcast:10 row_mask:0xf bank_mask:0xf
    v_add_u32_dpp v63, v34, v12 row_newbcast:11 row_mask:0xf bank_mask:0xf
    v_readlane_b32 s24, v8, 63
    s_lshr_b32 s24, s24, 23
    s_max_u32 s24, s24, 29
    s_min_u32 s24, s24, 254
    s_sub_u32 s25, 268, s24
    s_lshl_b32 s25, s25, 23
    s_sub_u32 s34, s24, 28
    s_lshl_b32 s34, s34, 23
    v_mul_f32 v220, s25, v220
    v_mul_f32 v221, s25, v221
    v_cvt_pk_f16_f32 v220, v220, v221
    v_add_u32 v19, 145728, v9
    v_lshrrev_b32 v6, 8, v34
    v_mul_u32_u24 v6, 544, v6
    v_add_u32 v23, v6, v23
    s_lshl_b32 s24, s51, 5
    v_cmp_gt_u32 s[8:9], s24, v30
    s_cmp_gt_u32 s30, 8
    s_cbranch_scc1 L_psel2
L_psel_back:
    s_waitcnt vmcnt(8)
    ds_write_b8 v41, v35
    ds_write_b32 v40, v2 offset:12
    ds_write_b128 v36, v[172:175]
    ds_write_b128 v36, v[176:179] offset:4096
    ds_write_b32 v39, v35
    ds_write_b32 v19, v220
    s_waitcnt lgkmcnt(0)
    s_barrier
    ds_read_b128 v[180:183], v52
    ds_read_b128 v[184:187], v52 offset:4096
    ds_read_b128 v[188:191], v53
    ds_read_b128 v[192:195], v53 offset:4096
    s_add_u32 m0, s35, 16640
    s_nop 0
    buffer_load_dwordx4 v76, s[36:39], 0 offen nt lds
    s_add_u32 m0, s35, 17680
    s_nop 0
    buffer_load_dwordx4 v77, s[36:39], 0 offen nt lds
    ds_read_b128 v[196:199], v54
    ds_read_b128 v[200:203], v54 offset:4096
    ds_read_b128 v[204:207], v55
    ds_read_b128 v[208:211], v55 offset:4096
    ds_read_b32 v26, v26
    s_waitcnt lgkmcnt(0)
    v_lshlrev_b32 v20, 16, s33
    v_bfe_u32 v6, v26, 4, 4
    v_and_b32 v29, 0xffff0000, v26
    v_mul_u32_u24 v6, 160, v6
    v_add_u32 v28, v6, v28
    s_setprio 2
    s_waitcnt vmcnt(8)
    ds_read_b128 v[172:175], v13 offset:0
    ds_read_b128 v[176:179], v13 offset:1040
    s_barrier
    s_mov_b32 m0, s50
    s_waitcnt lgkmcnt(1)
    v_lshlrev_b32 v224, 16, v172
    v_and_b32 v225, v42, v172
    v_lshlrev_b32 v226, 16, v173
    v_and_b32 v227, v42, v173
    v_lshlrev_b32 v228, 16, v174
    v_and_b32 v229, v42, v174
    v_lshlrev_b32 v230, 16, v175
    v_and_b32 v231, v42, v175
    v_mul_f32 v224, v224, v180
    v_mul_f32 v225, v225, v181
    v_mul_f32 v226, v226, v182
    v_mul_f32 v227, v227, v183
    v_mul_f32 v228, v228, v184
    v_mul_f32 v229, v229, v185
    v_mul_f32 v230, v230, v186
    v_mul_f32 v231, v231, v187
    v_cvt_pk_bf16_f32 v212, v224, v225
    v_cvt_pk_bf16_f32 v213, v226, v227
    v_cvt_pk_bf16_f32 v214, v228, v229
    v_cvt_pk_bf16_f32 v215, v230, v231
    s_waitcnt lgkmcnt(0)
    v_lshlrev_b32 v224, 16, v176
    v_and_b32 v225, v42, v176
    v_lshlrev_b32 v226, 16, v177
    v_and_b32 v227, v42, v177
    v_lshlrev_b32 v228, 16, v178
    v_and_b32 v229, v42, v178
    v_lshlrev_b32 v230, 16, v179
    v_and_b32 v231, v42, v179
    v_mul_f32 v224, v224, v188
    v_mul_f32 v225, v225, v189
    v_mul_f32 v226, v226, v190
    v_mul_f32 v227, v227, v191
    v_mul_f32 v228, v228, v192
    v_mul_f32 v229, v229, v193
    v_mul_f32 v230, v230, v194
    v_mul_f32_e64 v231, v231, v195
    v_cvt_pk_bf16_f32 v216, v224, v225
    v_cvt_pk_bf16_f32 v217, v226, v227
    v_cvt_pk_bf16_f32 v218, v228, v229
    v_cvt_pk_bf16_f32 v219, v230, v231
    ds_write_addtid_b32 v212 offset:0
    ds_write_addtid_b32 v213 offset:256
    ds_write_addtid_b32 v214 offset:512
    ds_write_addtid_b32 v215 offset:768
    ds_write_addtid_b32 v216 offset:1040
    ds_write_addtid_b32 v217 offset:1296
    ds_write_addtid_b32 v218 offset:1552
    ds_write_addtid_b32 v219 offset:1808
    s_cbranch_vccnz L_light0
    s_add_u32 m0, s35, 24960
    s_nop 0
    buffer_load_dwordx4 v78, s[36:39], 0 offen nt lds
    s_add_u32 m0, s35, 26000
    s_nop 0
    buffer_load_dwordx4 v79, s[36:39], 0 offen nt lds
    s_waitcnt vmcnt(4)
L_join0:
    ds_read_b128 v[172:175], v13 offset:8320
    ds_read_b128 v[176:179], v13 offset:9360
    s_waitcnt lgkmcnt(2)
    s_setprio 0
    s_barrier
    s_mov_b32 m0, s50
    s_waitcnt lgkmcnt(1)
    v_lshlrev_b32 v224, 16, v172
    v_and_b32 v225, v42, v172
    v_lshlrev_b32 v226, 16, v173
    v_and_b32 v227, v42, v173
    v_lshlrev_b32 v228, 16, v174
    v_and_b32 v229, v42, v174
    v_lshlrev_b32 v230, 16, v175
    v_and_b32 v231, v42, v175
    v_mul_f32 v224, v224, v196
    v_mul_f32 v225, v225, v197
    v_mul_f32 v226, v226, v198
    v_mul_f32 v227, v227, v199
    v_mul_f32 v228, v228, v200
    v_mul_f32 v229, v229, v201
    v_mul_f32 v230, v230, v202
    v_mul_f32_e64 v231, v231, v203
    v_cvt_pk_bf16_f32 v212, v224, v225
    v_cvt_pk_bf16_f32 v213, v226, v227
    v_cvt_pk_bf16_f32 v214, v228, v229
    v_cvt_pk_bf16_f32 v215, v230, v231
    s_waitcnt lgkmcnt(0)
    v_lshlrev_b32 v224, 16, v176
    v_and_b32 v225, v42, v176
    v_lshlrev_b32 v226, 16, v177
    v_and_b32 v227, v42, v177
    v_lshlrev_b32 v228, 16, v178
    v_and_b32 v229, v42, v178
    v_lshlrev_b32 v230, 16, v179
    v_and_b32 v231, v42, v179
    v_mul_f32 v224, v224, v204
    v_mul_f32 v225, v225, v205
    v_mul_f32 v226, v226, v206
    v_mul_f32 v227, v227, v207
    v_mul_f32 v228, v228, v208
    v_mul_f32 v229, v229, v209
    v_mul_f32 v230, v230, v210
    v_mul_f32_e64 v231, v231, v211
    v_cvt_pk_bf16_f32 v216, v224, v225
    v_cvt_pk_bf16_f32 v217, v226, v227
    v_cvt_pk_bf16_f32 v218, v228, v229
    v_cvt_pk_bf16_f32 v219, v230, v231
    ds_write_addtid_b32 v212 offset:8320
    ds_write_addtid_b32 v213 offset:8576
    ds_write_addtid_b32 v214 offset:8832
    ds_write_addtid_b32 v215 offset:9088
    ds_write_addtid_b32 v216 offset:9360
    ds_write_addtid_b32 v217 offset:9616
    ds_write_addtid_b32 v218 offset:9872
    ds_write_addtid_b32 v219 offset:10128
    s_cmp_eq_u32 s30, 2
    s_cbranch_scc1 L_pshort
    ds_read_b128 v[180:183], v56
    ds_read_b128 v[184:187], v56 offset:4096
    ds_read_b128 v[188:191], v57
    ds_read_b128 v[192:195], v57 offset:4096
    s_cbranch_vccnz L_light1
    s_add_u32 m0, s35, 33280
    s_nop 0
    buffer_load_dwordx4 v80, s[36:39], 0 offen nt lds
    s_add_u32 m0, s35, 34320
    s_nop 0
    buffer_load_dwordx4 v81, s[36:39], 0 offen nt lds
    s_waitcnt vmcnt(4)
L_join1:
    ds_read_b128 v[172:175], v13 offset:16640
    ds_read_b128 v[176:179], v13 offset:17680
    s_waitcnt lgkmcnt(6)
    s_barrier
    ds_read_b128 v[196:199], v58
    ds_read_b128 v[200:203], v58 offset:4096
    ds_read_b128 v[204:207], v59
    ds_read_b128 v[208:211], v59 offset:4096
    s_mov_b32 m0, s50
    s_waitcnt lgkmcnt(4)
    v_lshlrev_b32 v156, 16, v172
    v_and_b32 v157, v42, v172
    v_lshlrev_b32 v158, 16, v173
    v_and_b32 v159, v42, v173
    s_setprio 2
    v_lshlrev_b32 v160, 16, v174
    v_and_b32 v161, v42, v174
    v_lshlrev_b32 v162, 16, v175
    v_and_b32 v163, v42, v175
    v_lshlrev_b32 v164, 16, v176
    v_and_b32 v165, v42, v176
    v_lshlrev_b32 v166, 16, v177
    v_and_b32 v167, v42, v177
    v_lshlrev_b32 v168, 16, v178
    v_and_b32 v169, v42, v178
    v_lshlrev_b32 v170, 16, v179
    v_and_b32_e64 v171, v42, v179
    v_pk_mul_f32 v[156:157], v[156:157], v[180:181]
    v_pk_mul_f32 v[158:159], v[158:159], v[182:183]
    v_pk_mul_f32 v[160:161], v[160:161], v[184:185]
    v_pk_mul_f32 v[162:163], v[162:163], v[186:187]
    v_pk_mul_f32 v[164:165], v[164:165], v[188:189]
    v_pk_mul_f32 v[166:167], v[166:167], v[190:191]
    v_pk_mul_f32 v[168:169], v[168:169], v[192:193]
    v_pk_mul_f32 v[170:171], v[170:171], v[194:195]
    s_setprio 0
    v_cvt_pk_bf16_f32 v212, v156, v157
    v_cvt_pk_bf16_f32 v213, v158, v159
    v_cvt_pk_bf16_f32 v214, v160, v161
    v_cvt_pk_bf16_f32 v215, v162, v163
    v_cvt_pk_bf16_f32 v216, v164, v165
    v_cvt_pk_bf16_f32 v217, v166, v167
    v_cvt_pk_bf16_f32 v218, v168, v169
    v_cvt_pk_bf16_f32 v219, v170, v171
    ds_write_addtid_b32 v212 offset:0
    ds_write_addtid_b32 v213 offset:256
    ds_write_addtid_b32 v214 offset:512
    ds_write_addtid_b32 v215 offset:768
    ds_write_addtid_b32 v216 offset:1040
    ds_write_addtid_b32 v217 offset:1296
    ds_write_addtid_b32 v218 offset:1552
    ds_write_addtid_b32 v219 offset:1808
    s_cmp_eq_u32 s30, 3
    s_cbranch_scc1 L_pdone
    s_cmp_gt_u32 s30, 6
    s_cbranch_scc1 L_pmore
    s_cbranch_vccnz L_join2
    s_add_u32 m0, s35, 41600
    s_nop 0
    buffer_load_dwordx4 v82, s[36:39], 0 offen nt lds
    s_add_u32 m0, s35, 42640
    s_nop 0
    buffer_load_dwordx4 v83, s[36:39], 0 offen nt lds
    s_waitcnt vmcnt(4)
L_join2:
    ds_read_b128 v[172:175], v13 offset:24960
    ds_read_b128 v[176:179], v13 offset:26000
    s_waitcnt lgkmcnt(2)
    s_barrier
    ds_read_b128 v[180:183], v60
    ds_read_b128 v[184:187], v60 offset:4096
    ds_read_b128 v[188:191], v61
    ds_read_b128 v[192:195], v61 offset:4096
    s_mov_b32 m0, s50
    s_waitcnt lgkmcnt(4)
    v_lshlrev_b32 v156, 16, v172
    v_and_b32 v157, v42, v172
    v_lshlrev_b32 v158, 16, v173
    v_and_b32 v159, v42, v173
    v_lshlrev_b32 v160, 16, v174
    v_and_b32 v161, v42, v174
    s_setprio 2
    v_lshlrev_b32 v162, 16, v175
    v_and_b32 v163, v42, v175
    v_lshlrev_b32 v164, 16, v176
    v_and_b32 v165, v42, v176
    v_lshlrev_b32 v166, 16, v177
    v_and_b32 v167, v42, v177
    v_lshlrev_b32 v168, 16, v178
    v_and_b32 v169, v42, v178
    v_lshlrev_b32 v170, 16, v179
    v_and_b32 v171, v42, v179
    v_pk_mul_f32 v[156:157], v[156:157], v[196:197]
    v_pk_mul_f32 v[158:159], v[158:159], v[198:199]
    v_pk_mul_f32 v[160:161], v[160:161], v[200:201]
    v_pk_mul_f32 v[162:163], v[162:163], v[202:203]
    v_pk_mul_f32 v[164:165], v[164:165], v[204:205]
    v_pk_mul_f32 v[166:167], v[166:167], v[206:207]
    v_pk_mul_f32 v[168:169], v[168:169], v[208:209]
    v_pk_mul_f32 v[170:171], v[170:171], v[210:211]
    s_setprio 0
    v_cvt_pk_bf16_f32 v212, v156, v157
    v_cvt_pk_bf16_f32 v213, v158, v159
    v_cvt_pk_bf16_f32 v214, v160, v161
    v_cvt_pk_bf16_f32 v215, v162, v163
    v_cvt_pk_bf16_f32 v216, v164, v165
    v_cvt_pk_bf16_f32 v217, v166, v167
    v_cvt_pk_bf16_f32 v218, v168, v169
    v_cvt_pk_bf16_f32 v219, v170, v171
    ds_write_addtid_b32 v212 offset:8320
    ds_write_addtid_b32 v213 offset:8576
    ds_write_addtid_b32 v214 offset:8832
    ds_write_addtid_b32 v215 offset:9088
    ds_write_addtid_b32 v216 offset:9360
    ds_write_addtid_b32 v217 offset:9616
    ds_write_addtid_b32 v218 offset:9872
    ds_write_addtid_b32 v219 offset:10128
    s_cmp_eq_u32 s30, 4
    s_cbranch_scc1 L_pdone
    s_waitcnt vmcnt(2)
    ds_read_b128 v[172:175], v13 offset:33280
    ds_read_b128 v[176:179], v13 offset:34320
    s_waitcnt lgkmcnt(2)
    s_barrier
    ds_read_b128 v[196:199], v62
    ds_read_b128 v[200:203], v62 offset:4096
    ds_read_b128 v[204:207], v63
    ds_read_b128 v[208:211], v63 offset:4096
    s_mov_b32 m0, s50
    s_waitcnt lgkmcnt(4)
    v_lshlrev_b32 v156, 16, v172
    v_and_b32 v157, v42, v172
    v_lshlrev_b32 v158, 16, v173
    v_and_b32 v159, v42, v173
    v_lshlrev_b32 v160, 16, v174
    v_and_b32 v161, v42, v174
    v_lshlrev_b32 v162, 16, v175
    v_and_b32 v163, v42, v175
    v_lshlrev_b32 v164, 16, v176
    s_setprio 2
    v_and_b32 v165, v42, v176
    v_lshlrev_b32 v166, 16, v177
    v_and_b32 v167, v42, v177
    v_lshlrev_b32 v168, 16, v178
    v_and_b32 v169, v42, v178
    v_lshlrev_b32 v170, 16, v179
    v_and_b32_e64 v171, v42, v179
    v_pk_mul_f32 v[156:157], v[156:157], v[180:181]
    v_pk_mul_f32 v[158:159], v[158:159], v[182:183]
    v_pk_mul_f32 v[160:161], v[160:161], v[184:185]
    v_pk_mul_f32 v[162:163], v[162:163], v[186:187]
    v_pk_mul_f32 v[164:165], v[164:165], v[188:189]
    v_pk_mul_f32 v[166:167], v[166:167], v[190:191]
    v_pk_mul_f32 v[168:169], v[168:169], v[192:193]
    v_pk_mul_f32 v[170:171], v[170:171], v[194:195]
    s_setprio 0
    v_cvt_pk_bf16_f32 v212, v156, v157
    v_cvt_pk_bf16_f32 v213, v158, v159
    v_cvt_pk_bf16_f32 v214, v160, v161
    v_cvt_pk_bf16_f32 v215, v162, v163
    v_cvt_pk_bf16_f32 v216, v164, v165
    v_cvt_pk_bf16_f32 v217, v166, v167
    v_cvt_pk_bf16_f32 v218, v168, v169
    v_cvt_pk_bf16_f32 v219, v170, v171
    ds_write_addtid_b32 v212 offset:0
    ds_write_addtid_b32 v213 offset:256
    ds_write_addtid_b32 v214 offset:512
    ds_write_addtid_b32 v215 offset:768
    ds_write_addtid_b32 v216 offset:1040
    ds_write_addtid_b32 v217 offset:1296
    ds_write_addtid_b32 v218 offset:1552
    ds_write_addtid_b32 v219 offset:1808
    s_cmp_eq_u32 s30, 5
    s_cbranch_scc1 L_pdone
    s_waitcnt vmcnt(0)
    ds_read_b128 v[172:175], v13 offset:41600
    ds_read_b128 v[176:179], v13 offset:42640
    s_waitcnt lgkmcnt(2)
    s_barrier
    s_mov_b32 m0, s50
    s_waitcnt lgkmcnt(0)
    v_lshlrev_b32 v156, 16, v172
    v_and_b32 v157, v42, v172
    v_lshlrev_b32 v158, 16, v173
    v_and_b32 v159, v42, v173
    v_lshlrev_b32 v160, 16, v174
    v_and_b32 v161, v42, v174
    v_lshlrev_b32 v162, 16, v175
    v_and_b32 v163, v42, v175
    v_lshlrev_b32 v164, 16, v176
    s_setprio 2
    v_and_b32 v165, v42, v176
    v_lshlrev_b32 v166, 16, v177
    v_and_b32 v167, v42, v177
    v_lshlrev_b32 v168, 16, v178
    v_and_b32 v169, v42, v178
    v_lshlrev_b32 v170, 16, v179
    v_and_b32_e64 v171, v42, v179
    v_pk_mul_f32 v[156:157], v[156:157], v[196:197]
    v_pk_mul_f32 v[158:159], v[158:159], v[198:199]
    v_pk_mul_f32 v[160:161], v[160:161], v[200:201]
    v_pk_mul_f32 v[162:163], v[162:163], v[202:203]
    v_pk_mul_f32 v[164:165], v[164:165], v[204:205]
    v_pk_mul_f32 v[166:167], v[166:167], v[206:207]
    v_pk_mul_f32 v[168:169], v[168:169], v[208:209]
    v_pk_mul_f32 v[170:171], v[170:171], v[210:211]
    s_setprio 0
    v_cvt_pk_bf16_f32 v212, v156, v157
    v_cvt_pk_bf16_f32 v213, v158, v159
    v_cvt_pk_bf16_f32 v214, v160, v161
    v_cvt_pk_bf16_f32 v215, v162, v163
    v_cvt_pk_bf16_f32 v216, v164, v165
    v_cvt_pk_bf16_f32 v217, v166, v167
    v_cvt_pk_bf16_f32 v218, v168, v169
    v_cvt_pk_bf16_f32 v219, v170, v171
    ds_write_addtid_b32 v212 offset:8320
    ds_write_addtid_b32 v213 offset:8576
    ds_write_addtid_b32 v214 offset:8832
    ds_write_addtid_b32 v215 offset:9088
    ds_write_addtid_b32 v216 offset:9360
    ds_write_addtid_b32 v217 offset:9616
    ds_write_addtid_b32 v218 offset:9872
    ds_write_addtid_b32 v219 offset:10128
L_pdone:
    s_waitcnt vmcnt(0) lgkmcnt(0)
    s_barrier
L_pdone2:
    s_setprio 0
    s_cmp_gt_u32 s30, 6
    s_cbranch_scc1 L_ptr2
    ds_read_b64_tr_b16 v[92:93], v14 offset:0
    ds_read_b64_tr_b16 v[94:95], v14 offset:1040
    ds_read_b64_tr_b16 v[96:97], v14 offset:32
    ds_read_b64_tr_b16 v[98:99], v14 offset:1072
    ds_read_b64_tr_b16 v[100:101], v14 offset:8320
    ds_read_b64_tr_b16 v[102:103], v14 offset:9360
    ds_read_b64_tr_b16 v[104:105], v14 offset:8352
    ds_read_b64_tr_b16 v[106:107], v14 offset:9392
    ds_read_b64_tr_b16 v[108:109], v14 offset:16640
    ds_read_b64_tr_b16 v[110:111], v14 offset:17680
    ds_read_b64_tr_b16 v[112:113], v14 offset:16672
    ds_read_b64_tr_b16 v[114:115], v14 offset:17712
    ds_read_b64_tr_b16 v[116:117], v14 offset:24960
    ds_read_b64_tr_b16 v[118:119], v14 offset:26000
    ds_read_b64_tr_b16 v[120:121], v14 offset:24992
    s_waitcnt lgkmcnt(8)
    ds_read_b64_tr_b16 v[122:123], v14 offset:26032
    ds_read_b64_tr_b16 v[156:157], v15 offset:0
    ds_read_b64_tr_b16 v[158:159], v15 offset:1040
    ds_read_b64_tr_b16 v[160:161], v15 offset:32
    ds_read_b64_tr_b16 v[162:163], v15 offset:1072
    ds_read_b64_tr_b16 v[164:165], v16 offset:0
    ds_read_b64_tr_b16 v[166:167], v16 offset:1040
    s_waitcnt lgkmcnt(8)
    ds_read_b64_tr_b16 v[168:169], v16 offset:32
    ds_read_b64_tr_b16 v[170:171], v16 offset:1072
    s_setprio 2
    s_barrier
    ds_read_b128 v[220:223], v22
    s_waitcnt lgkmcnt(0)
    v_add_f32 v220, v220, v221
    v_add_f32 v222, v222, v223
    v_add_f32 v220, v220, v222
    v_fma_f32 v220, v220, s34, v20
    v_mul_f32 v220, v220, v24
    v_cvt_pk_bf16_f32 v220, v220, v220
    s_mov_b64 exec, s[8:9]
    ds_write_b16 v23, v220
    s_mov_b64 exec, -1
    s_waitcnt lgkmcnt(0)
    s_setprio 0
    s_barrier
    ds_read_b128 v[180:183], v17 offset:0
    ds_read_b128 v[184:187], v17 offset:64
    ds_read_b128 v[188:191], v17 offset:128
    ds_read_b128 v[192:195], v17 offset:192
L_psum_back:
    s_waitcnt lgkmcnt(3)
    v_mfma_f32_16x16x32_bf16 v[232:235], v[92:95], v[180:183], v[232:235]
    v_mfma_f32_16x16x32_bf16 v[236:239], v[96:99], v[180:183], v[236:239]
    s_waitcnt lgkmcnt(2)
    v_mfma_f32_16x16x32_bf16 v[232:235], v[100:103], v[184:187], v[232:235]
    v_mfma_f32_16x16x32_bf16 v[236:239], v[104:107], v[184:187], v[236:239]
    s_waitcnt lgkmcnt(1)
    v_mfma_f32_16x16x32_bf16 v[232:235], v[108:111], v[188:191], v[232:235]
    v_mfma_f32_16x16x32_bf16 v[236:239], v[112:115], v[188:191], v[236:239]
    s_waitcnt lgkmcnt(0)
    v_mfma_f32_16x16x32_bf16 v[232:235], v[116:119], v[192:195], v[232:235]
    v_mfma_f32_16x16x32_bf16 v[236:239], v[120:123], v[192:195], v[236:239]
    s_setprio 2
    s_barrier
    ds_read_b128 v[220:223], v27
    s_waitcnt lgkmcnt(0)
    v_pk_add_f32 v[220:221], v[220:221], v[222:223]
    v_add_f32 v220, v220, v221
    v_fma_f32 v220, v220, s34, v20
    v_mul_f32_e64 v220, v220, v29
    v_cvt_pk_bf16_f32 v220, v220, v220
    ds_write_b16 v28, v220
    ds_read_b128 v[224:227], v18 offset:0
    ds_read_b128 v[228:231], v18 offset:64
    s_waitcnt lgkmcnt(1)
    v_mfma_f32_16x16x32_bf16 v[232:235], v[156:159], v[224:227], v[232:235]
    s_waitcnt lgkmcnt(0)
    v_mfma_f32_16x16x32_bf16 v[232:235], v[164:167], v[228:231], v[232:235]
    v_mfma_f32_16x16x32_bf16 v[236:239], v[160:163], v[224:227], v[236:239]
    v_mfma_f32_16x16x32_bf16 v[236:239], v[168:171], v[228:231], v[236:239]
    s_nop 5
    v_cvt_pk_bf16_f32 v212, v232, v233
    v_cvt_pk_bf16_f32 v213, v234, v235
    v_cvt_pk_bf16_f32 v214, v236, v237
    v_cvt_pk_bf16_f32 v215, v238, v239
    ds_write_b64 v43, v[212:213]
    ds_write_b64 v43, v[214:215] offset:32
    ds_read_b128 v[216:219], v44
    s_waitcnt lgkmcnt(0)
    global_store_dwordx4 v25, v[216:219], s[18:19] sc1
    s_endpgm
L_light0:
    s_add_u32 m0, s35, 24960
    s_nop 0
    buffer_load_dwordx4 v78, s[36:39], 0 offen nt lds
    s_add_u32 m0, s35, 26000
    s_nop 0
    buffer_load_dwordx4 v79, s[36:39], 0 offen nt lds
    s_add_u32 m0, s35, 33280
    s_nop 0
    buffer_load_dwordx4 v80, s[36:39], 0 offen nt lds
    s_add_u32 m0, s35, 34320
    s_nop 0
    buffer_load_dwordx4 v81, s[36:39], 0 offen nt lds
    s_waitcnt vmcnt(6)
    s_branch L_join0
L_light1:
    s_waitcnt vmcnt(0)
    s_branch L_join1
L_pshort:
    s_waitcnt vmcnt(0) lgkmcnt(0)
    s_barrier
    s_branch L_pdone2
.p2align 12
L_cons:
    s_add_u32 m0, s28, 17408
    s_mov_b32 s31, 16384
    buffer_load_dwordx4 v1, s[20:23], s31 offen offset:0 lds
    buffer_load_dwordx4 v2, s[20:23], s31 offen offset:1024 lds
    s_add_u32 m0, s28, 50176
    s_mov_b32 s31, 81920
    buffer_load_dwordx4 v1, s[20:23], s31 offen offset:0 lds
    buffer_load_dwordx4 v2, s[20:23], s31 offen offset:1024 lds
    s_waitcnt vmcnt(8)
    ds_read_b64_tr_b16 v[36:37], v7 offset:0
    ds_read_b64_tr_b16 v[38:39], v7 offset:256
    ds_read_b64_tr_b16 v[100:101], v7 offset:32768
    ds_read_b64_tr_b16 v[102:103], v7 offset:33024
    ds_read_b64_tr_b16 v[40:41], v7 offset:1024
    ds_read_b64_tr_b16 v[42:43], v7 offset:1280
    ds_read_b64_tr_b16 v[104:105], v7 offset:33792
    ds_read_b64_tr_b16 v[106:107], v7 offset:34048
    s_add_u32 m0, s28, 25600
    s_mov_b32 s31, 24576
    buffer_load_dwordx4 v1, s[20:23], s31 offen offset:0 lds
    buffer_load_dwordx4 v2, s[20:23], s31 offen offset:1024 lds
    s_waitcnt lgkmcnt(4)
    v_lshlrev_b32 v228, 16, v36
    v_and_b32 v229, v5, v36
    v_lshlrev_b32 v230, 16, v37
    v_and_b32 v231, v5, v37
    v_lshlrev_b32 v232, 16, v38
    v_and_b32 v233, v5, v38
    v_lshlrev_b32 v234, 16, v39
    s_add_u32 m0, s28, 58368
    s_mov_b32 s31, 90112
    buffer_load_dwordx4 v1, s[20:23], s31 offen offset:0 lds
    v_and_b32 v235, v5, v39
    v_dot2c_f32_bf16 v228, v100, v3
    v_dot2c_f32_bf16 v229, v100, v4
    v_dot2c_f32_bf16 v230, v101, v3
    v_dot2c_f32_bf16 v231, v101, v4
    v_dot2c_f32_bf16 v232, v102, v3
    v_dot2c_f32_bf16 v233, v102, v4
    v_dot2c_f32_bf16 v234, v103, v3
    buffer_load_dwordx4 v2, s[20:23], s31 offen offset:1024 lds
    v_dot2c_f32_bf16 v235, v103, v4
    v_pk_mul_f32 v[228:229], v[228:229], s[24:25]
    v_pk_mul_f32 v[230:231], v[230:231], s[24:25]
    v_pk_mul_f32 v[232:233], v[232:233], s[24:25]
    v_pk_mul_f32 v[234:235], v[234:235], s[24:25]
    v_cvt_pk_bf16_f32 v36, v228, v229
    v_cvt_pk_bf16_f32 v37, v230, v231
    v_cvt_pk_bf16_f32 v38, v232, v233
    v_cvt_pk_bf16_f32 v39, v234, v235
    s_waitcnt vmcnt(8)
    ds_read_b64_tr_b16 v[44:45], v7 offset:8192
    ds_read_b64_tr_b16 v[46:47], v7 offset:8448
    ds_read_b64_tr_b16 v[108:109], v7 offset:40960
    ds_read_b64_tr_b16 v[110:111], v7 offset:41216
    ds_read_b64_tr_b16 v[48:49], v7 offset:9216
    ds_read_b64_tr_b16 v[50:51], v7 offset:9472
    ds_read_b64_tr_b16 v[112:113], v7 offset:41984
    ds_read_b64_tr_b16 v[114:115], v7 offset:42240
    s_add_u32 m0, s28, 66560
    s_mov_b32 s31, 32768
    buffer_load_dwordx4 v1, s[20:23], s31 offen offset:0 lds
    buffer_load_dwordx4 v2, s[20:23], s31 offen offset:1024 lds
    s_waitcnt lgkmcnt(8)
    v_lshlrev_b32 v228, 16, v40
    v_and_b32 v229, v5, v40
    v_lshlrev_b32 v230, 16, v41
    v_and_b32 v231, v5, v41
    v_lshlrev_b32 v232, 16, v42
    v_and_b32 v233, v5, v42
    v_lshlrev_b32 v234, 16, v43
    s_add_u32 m0, s28, 74752
    s_mov_b32 s31, 40960
    buffer_load_dwordx4 v1, s[20:23], s31 offen offset:0 lds
    v_and_b32 v235, v5, v43
    v_dot2c_f32_bf16 v228, v104, v3
    v_dot2c_f32_bf16 v229, v104, v4
    v_dot2c_f32_bf16 v230, v105, v3
    v_dot2c_f32_bf16 v231, v105, v4
    v_dot2c_f32_bf16 v232, v106, v3
    v_dot2c_f32_bf16 v233, v106, v4
    v_dot2c_f32_bf16 v234, v107, v3
    buffer_load_dwordx4 v2, s[20:23], s31 offen offset:1024 lds
    v_dot2c_f32_bf16 v235, v107, v4
    v_pk_mul_f32 v[228:229], v[228:229], s[24:25]
    v_pk_mul_f32 v[230:231], v[230:231], s[24:25]
    v_pk_mul_f32 v[232:233], v[232:233], s[24:25]
    v_pk_mul_f32 v[234:235], v[234:235], s[24:25]
    v_cvt_pk_bf16_f32 v40, v228, v229
    v_cvt_pk_bf16_f32 v41, v230, v231
    v_cvt_pk_bf16_f32 v42, v232, v233
    v_cvt_pk_bf16_f32 v43, v234, v235
    s_waitcnt lgkmcnt(2)
    s_waitcnt vmcnt(8)
    ds_read_b64_tr_b16 v[52:53], v7 offset:16384
    ds_read_b64_tr_b16 v[54:55], v7 offset:16640
    ds_read_b64_tr_b16 v[116:117], v7 offset:49152
    ds_read_b64_tr_b16 v[118:119], v7 offset:49408
    ds_read_b64_tr_b16 v[56:57], v7 offset:17408
    ds_read_b64_tr_b16 v[58:59], v7 offset:17664
    ds_read_b64_tr_b16 v[120:121], v7 offset:50176
    ds_read_b64_tr_b16 v[122:123], v7 offset:50432
    s_add_u32 m0, s28, 82944
    s_mov_b32 s31, 49152
    buffer_load_dwordx4 v1, s[20:23], s31 offen offset:0 lds
    v_lshlrev_b32 v228, 16, v44
    v_and_b32 v229, v5, v44
    v_lshlrev_b32 v230, 16, v45
    v_and_b32 v231, v5, v45
    v_lshlrev_b32 v232, 16, v46
    v_and_b32 v233, v5, v46
    v_lshlrev_b32 v234, 16, v47
    v_and_b32 v235, v5, v47
    buffer_load_dwordx4 v2, s[20:23], s31 offen offset:1024 lds
    v_dot2c_f32_bf16 v228, v108, v3
    v_dot2c_f32_bf16 v229, v108, v4
    v_dot2c_f32_bf16 v230, v109, v3
    v_dot2c_f32_bf16 v231, v109, v4
    v_dot2c_f32_bf16 v232, v110, v3
    v_dot2c_f32_bf16 v233, v110, v4
    v_dot2c_f32_bf16 v234, v111, v3
    v_dot2c_f32_bf16 v235, v111, v4
    s_add_u32 m0, s28, 91136
    s_mov_b32 s31, 57344
    buffer_load_dwordx4 v1, s[20:23], s31 offen offset:0 lds
    v_pk_mul_f32 v[228:229], v[228:229], s[24:25]
    v_pk_mul_f32 v[230:231], v[230:231], s[24:25]
    v_pk_mul_f32 v[232:233], v[232:233], s[24:25]
    v_pk_mul_f32 v[234:235], v[234:235], s[24:25]
    v_cvt_pk_bf16_f32 v44, v228, v229
    v_cvt_pk_bf16_f32 v45, v230, v231
    v_cvt_pk_bf16_f32 v46, v232, v233
    v_cvt_pk_bf16_f32 v47, v234, v235
    buffer_load_dwordx4 v2, s[20:23], s31 offen offset:1024 lds
    s_barrier
    s_waitcnt vmcnt(8)
    ds_read_b64_tr_b16 v[60:61], v7 offset:24576
    ds_read_b64_tr_b16 v[62:63], v7 offset:24832
    ds_read_b64_tr_b16 v[124:125], v7 offset:57344
    ds_read_b64_tr_b16 v[126:127], v7 offset:57600
    ds_read_b64_tr_b16 v[64:65], v7 offset:25600
    s_waitcnt lgkmcnt(8)
    ds_read_b64_tr_b16 v[66:67], v7 offset:25856
    ds_read_b64_tr_b16 v[128:129], v7 offset:58368
    ds_read_b64_tr_b16 v[130:131], v7 offset:58624
    ds_read_b128 v[196:199], v196
    ds_read_b128 v[200:203], v200
    ds_read_b128 v[204:207], v204
    ds_read_b128 v[208:211], v208
    s_waitcnt lgkmcnt(8)
    ds_read_b64 v[214:215], v15
    ds_read_b64 v[218:219], v15 offset:32
    v_lshlrev_b32 v228, 16, v48
    v_and_b32 v229, v5, v48
    v_lshlrev_b32 v230, 16, v49
    v_and_b32 v231, v5, v49
    v_lshlrev_b32 v232, 16, v50
    v_and_b32 v233, v5, v50
    v_lshlrev_b32 v234, 16, v51
    v_and_b32 v235, v5, v51
    v_dot2c_f32_bf16 v228, v112, v3
    v_dot2c_f32_bf16 v229, v112, v4
    v_dot2c_f32_bf16 v230, v113, v3
    v_dot2c_f32_bf16 v231, v113, v4
    v_dot2c_f32_bf16 v232, v114, v3
    v_dot2c_f32_bf16 v233, v114, v4
    v_dot2c_f32_bf16 v234, v115, v3
    v_dot2c_f32_bf16 v235, v115, v4
    v_pk_mul_f32 v[228:229], v[228:229], s[24:25]
    v_pk_mul_f32 v[230:231], v[230:231], s[24:25]
    v_pk_mul_f32 v[232:233], v[232:233], s[24:25]
    v_pk_mul_f32 v[234:235], v[234:235], s[24:25]
    v_cvt_pk_bf16_f32 v48, v228, v229
    v_cvt_pk_bf16_f32 v49, v230, v231
    v_cvt_pk_bf16_f32 v50, v232, v233
    v_cvt_pk_bf16_f32 v51, v234, v235
    s_waitcnt lgkmcnt(0)
    ds_read_b64_tr_b16 v[132:133], v9 offset:32768
    ds_read_b64_tr_b16 v[134:135], v9 offset:33024
    ds_read_b64_tr_b16 v[136:137], v10 offset:32768
    ds_read_b64_tr_b16 v[138:139], v10 offset:33024
    ds_read_b64_tr_b16 v[140:141], v9 offset:40960
    ds_read_b64_tr_b16 v[142:143], v9 offset:41216
    ds_read_b64_tr_b16 v[144:145], v10 offset:40960
    ds_read_b64_tr_b16 v[146:147], v10 offset:41216
    ds_read_b64_tr_b16 v[148:149], v9 offset:49152
    ds_read_b64_tr_b16 v[150:151], v9 offset:49408
    ds_read_b64_tr_b16 v[152:153], v10 offset:49152
    ds_read_b64_tr_b16 v[154:155], v10 offset:49408
    v_lshlrev_b32 v228, 16, v52
    v_and_b32 v229, v5, v52
    v_lshlrev_b32 v230, 16, v53
    v_and_b32 v231, v5, v53
    v_lshlrev_b32 v232, 16, v54
    v_and_b32 v233, v5, v54
    v_lshlrev_b32 v234, 16, v55
    v_and_b32_e64 v235, v5, v55
    v_dot2c_f32_bf16 v228, v116, v3
    v_dot2c_f32_bf16 v229, v116, v4
    v_dot2c_f32_bf16 v230, v117, v3
    v_dot2c_f32_bf16 v231, v117, v4
    v_dot2c_f32_bf16 v232, v118, v3
    v_dot2c_f32_bf16 v233, v118, v4
    v_dot2c_f32_bf16 v234, v119, v3
    v_dot2c_f32_bf16 v235, v119, v4
    v_pk_mul_f32 v[228:229], v[228:229], s[24:25]
    v_pk_mul_f32 v[230:231], v[230:231], s[24:25]
    v_pk_mul_f32 v[232:233], v[232:233], s[24:25]
    v_pk_mul_f32 v[234:235], v[234:235], s[24:25]
    v_cvt_pk_bf16_f32 v52, v228, v229
    v_cvt_pk_bf16_f32 v53, v230, v231
    v_cvt_pk_bf16_f32 v54, v232, v233
    v_cvt_pk_bf16_f32 v55, v234, v235
    s_waitcnt lgkmcnt(8)
    v_mfma_f32_16x16x32_bf16 v[220:223], v[132:135], v[196:199], v[248:251]
    ds_read_b64_tr_b16 v[156:157], v9 offset:57344
    ds_read_b64_tr_b16 v[158:159], v9 offset:57600
    v_lshlrev_b32 v212, 16, v214
    v_and_b32 v213, v5, v214
    v_mfma_f32_16x16x32_bf16 v[224:227], v[136:139], v[196:199], v[248:251]
    s_waitcnt lgkmcnt(6)
    ds_read_b64_tr_b16 v[160:161], v10 offset:57344
    ds_read_b64_tr_b16 v[162:163], v10 offset:57600
    v_lshlrev_b32 v214, 16, v215
    v_and_b32 v215, v5, v215
    v_mfma_f32_16x16x32_bf16 v[220:223], v[140:143], v[200:203], v[220:223]
    s_waitcnt vmcnt(4)
    ds_read_b64_tr_b16 v[164:165], v11 offset:0
    ds_read_b64_tr_b16 v[166:167], v11 offset:256
    v_lshlrev_b32 v216, 16, v218
    v_and_b32 v217, v5, v218
    v_mfma_f32_16x16x32_bf16 v[224:227], v[144:147], v[200:203], v[224:227]
    s_waitcnt lgkmcnt(6)
    ds_read_b64_tr_b16 v[168:169], v12 offset:0
    ds_read_b64_tr_b16 v[170:171], v12 offset:256
    v_lshlrev_b32 v218, 16, v219
    v_and_b32 v219, v5, v219
    v_mfma_f32_16x16x32_bf16 v[220:223], v[148:151], v[204:207], v[220:223]
    ds_read_b64_tr_b16 v[172:173], v11 offset:8192
    ds_read_b64_tr_b16 v[174:175], v11 offset:8448
    v_mfma_f32_16x16x32_bf16 v[224:227], v[152:155], v[204:207], v[224:227]
    s_waitcnt lgkmcnt(6)
    ds_read_b64_tr_b16 v[176:177], v12 offset:8192
    ds_read_b64_tr_b16 v[178:179], v12 offset:8448
    v_mfma_f32_16x16x32_bf16 v[220:223], v[156:159], v[208:211], v[220:223]
    s_waitcnt vmcnt(0)
    ds_read_b64_tr_b16 v[180:181], v11 offset:16384
    ds_read_b64_tr_b16 v[182:183], v11 offset:16640
    v_mfma_f32_16x16x32_bf16 v[224:227], v[160:163], v[208:211], v[224:227]
    s_waitcnt lgkmcnt(6)
    ds_read_b64_tr_b16 v[184:185], v12 offset:16384
    ds_read_b64_tr_b16 v[186:187], v12 offset:16640
    v_mfma_f32_16x16x32_bf16 v[212:215], v[164:167], v[196:199], v[212:215]
    ds_read_b64_tr_b16 v[188:189], v11 offset:24576
    ds_read_b64_tr_b16 v[190:191], v11 offset:24832
    v_mfma_f32_16x16x32_bf16 v[216:219], v[168:171], v[196:199], v[216:219]
    s_waitcnt lgkmcnt(6)
    ds_read_b64_tr_b16 v[192:193], v12 offset:24576
    ds_read_b64_tr_b16 v[194:195], v12 offset:24832
    v_mfma_f32_16x16x32_bf16 v[212:215], v[172:175], v[200:203], v[212:215]
    v_mfma_f32_16x16x32_bf16 v[216:219], v[176:179], v[200:203], v[216:219]
    s_waitcnt lgkmcnt(4)
    v_mfma_f32_16x16x32_bf16 v[212:215], v[180:183], v[204:207], v[212:215]
    v_mfma_f32_16x16x32_bf16 v[216:219], v[184:187], v[204:207], v[216:219]
    s_waitcnt lgkmcnt(0)
    v_mfma_f32_16x16x32_bf16 v[212:215], v[188:191], v[208:211], v[212:215]
    v_mfma_f32_16x16x32_bf16 v[216:219], v[192:195], v[208:211], v[216:219]
    s_nop 6
    v_pk_add_f32 v[212:213], v[212:213], v[220:221] neg_lo:[0,1] neg_hi:[0,1]
    v_pk_add_f32 v[214:215], v[214:215], v[222:223] neg_lo:[0,1] neg_hi:[0,1]
    v_pk_add_f32 v[216:217], v[216:217], v[224:225] neg_lo:[0,1] neg_hi:[0,1]
    v_pk_add_f32 v[218:219], v[218:219], v[226:227] neg_lo:[0,1] neg_hi:[0,1]
    v_pk_mul_f32 v[212:213], v[212:213], s[24:25]
    v_pk_mul_f32 v[214:215], v[214:215], s[24:25]
    v_pk_mul_f32 v[216:217], v[216:217], s[24:25]
    v_pk_mul_f32 v[218:219], v[218:219], s[24:25]
    ds_write_b128 v23, v[212:215]
    ds_write_b128 v23, v[216:219] offset:1024
    v_lshlrev_b32 v228, 16, v56
    v_and_b32 v229, v5, v56
    v_lshlrev_b32 v230, 16, v57
    v_and_b32 v231, v5, v57
    v_lshlrev_b32 v232, 16, v58
    v_and_b32 v233, v5, v58
    v_lshlrev_b32 v234, 16, v59
    v_and_b32_e64 v235, v5, v59
    v_dot2c_f32_bf16 v228, v120, v3
    v_dot2c_f32_bf16 v229, v120, v4
    v_dot2c_f32_bf16 v230, v121, v3
    v_dot2c_f32_bf16 v231, v121, v4
    v_dot2c_f32_bf16 v232, v122, v3
    v_dot2c_f32_bf16 v233, v122, v4
    v_dot2c_f32_bf16 v234, v123, v3
    v_dot2c_f32_bf16 v235, v123, v4
    v_pk_mul_f32 v[228:229], v[228:229], s[24:25]
    v_pk_mul_f32 v[230:231], v[230:231], s[24:25]
    v_pk_mul_f32 v[232:233], v[232:233], s[24:25]
    v_pk_mul_f32 v[234:235], v[234:235], s[24:25]
    v_cvt_pk_bf16_f32 v56, v228, v229
    v_cvt_pk_bf16_f32 v57, v230, v231
    v_cvt_pk_bf16_f32 v58, v232, v233
    v_cvt_pk_bf16_f32 v59, v234, v235
    v_lshlrev_b32 v228, 16, v60
    v_and_b32 v229, v5, v60
    v_lshlrev_b32 v230, 16, v61
    v_and_b32 v231, v5, v61
    v_lshlrev_b32 v232, 16, v62
    v_and_b32 v233, v5, v62
    v_lshlrev_b32 v234, 16, v63
    v_and_b32 v235, v5, v63
    v_dot2c_f32_bf16 v228, v124, v3
    v_dot2c_f32_bf16 v229, v124, v4
    v_dot2c_f32_bf16 v230, v125, v3
    v_dot2c_f32_bf16 v231, v125, v4
    v_dot2c_f32_bf16 v232, v126, v3
    v_dot2c_f32_bf16 v233, v126, v4
    v_dot2c_f32_bf16 v234, v127, v3
    v_dot2c_f32_bf16 v235, v127, v4
    v_pk_mul_f32 v[228:229], v[228:229], s[24:25]
    v_pk_mul_f32 v[230:231], v[230:231], s[24:25]
    v_pk_mul_f32 v[232:233], v[232:233], s[24:25]
    v_pk_mul_f32 v[234:235], v[234:235], s[24:25]
    v_cvt_pk_bf16_f32 v60, v228, v229
    v_cvt_pk_bf16_f32 v61, v230, v231
    v_cvt_pk_bf16_f32 v62, v232, v233
    v_cvt_pk_bf16_f32 v63, v234, v235
    v_lshlrev_b32 v228, 16, v64
    v_and_b32 v229, v5, v64
    v_lshlrev_b32 v230, 16, v65
    v_and_b32 v231, v5, v65
    v_lshlrev_b32 v232, 16, v66
    v_and_b32 v233, v5, v66
    v_lshlrev_b32 v234, 16, v67
    v_and_b32 v235, v5, v67
    v_dot2c_f32_bf16 v228, v128, v3
    v_dot2c_f32_bf16 v229, v128, v4
    v_dot2c_f32_bf16 v230, v129, v3
    v_dot2c_f32_bf16 v231, v129, v4
    v_dot2c_f32_bf16 v232, v130, v3
    v_dot2c_f32_bf16 v233, v130, v4
    v_dot2c_f32_bf16 v234, v131, v3
    v_dot2c_f32_bf16 v235, v131, v4
    v_pk_mul_f32 v[228:229], v[228:229], s[24:25]
    v_pk_mul_f32 v[230:231], v[230:231], s[24:25]
    v_pk_mul_f32 v[232:233], v[232:233], s[24:25]
    v_pk_mul_f32 v[234:235], v[234:235], s[24:25]
    v_cvt_pk_bf16_f32 v64, v228, v229
    v_cvt_pk_bf16_f32 v65, v230, v231
    v_cvt_pk_bf16_f32 v66, v232, v233
    v_cvt_pk_bf16_f32 v67, v234, v235
    s_barrier
    ds_read_b128 v[196:199], v26
    s_waitcnt lgkmcnt(0)
    v_or_b32_sdwa v26, v24, v196 dst_sel:DWORD dst_unused:UNUSED_PAD src0_sel:DWORD src1_sel:BYTE_0
    ds_read_b128 v[164:167], v26 offset:0
    ds_read_b128 v[168:171], v26 offset:512
    ds_read_b128 v[172:175], v26 offset:1024
    ds_read_b128 v[176:179], v26 offset:1536
    s_barrier
    ds_read_b128 v[100:103], v17 offset:0
    ds_read_b128 v[104:107], v17 offset:32
    ds_read_b128 v[108:111], v18 offset:0
    ds_read_b128 v[112:115], v18 offset:32
    ds_read_b128 v[116:119], v19 offset:0
    ds_read_b128 v[120:123], v19 offset:32
    ds_read_b128 v[124:127], v20 offset:0
    ds_read_b128 v[128:131], v20 offset:32
    s_waitcnt lgkmcnt(7)
    v_mfma_f32_32x32x16_bf16 v[132:147], v[36:39], v[100:103], v[164:179]
    s_waitcnt lgkmcnt(6)
    ds_read_b64_tr_b16 v[68:69], v8 offset:32768
    ds_read_b64_tr_b16 v[70:71], v8 offset:33024
    ds_read_b64_tr_b16 v[72:73], v8 offset:33792
    v_mfma_f32_32x32x16_bf16 v[132:147], v[40:43], v[104:107], v[132:147]
    s_waitcnt lgkmcnt(8)
    ds_read_b64_tr_b16 v[74:75], v8 offset:34048
    ds_read_b64_tr_b16 v[76:77], v8 offset:40960
    ds_read_b64_tr_b16 v[78:79], v8 offset:41216
    v_mfma_f32_32x32x16_bf16 v[132:147], v[44:47], v[108:111], v[132:147]
    s_waitcnt lgkmcnt(10)
    ds_read_b64_tr_b16 v[80:81], v8 offset:41984
    ds_read_b64_tr_b16 v[82:83], v8 offset:42240
    ds_read_b64 v[242:243], v236 offset:48
    v_mfma_f32_32x32x16_bf16 v[132:147], v[48:51], v[112:115], v[132:147]
    s_waitcnt lgkmcnt(12)
    ds_read_b64 v[240:241], v236 offset:32
    ds_read_b64 v[238:239], v236 offset:16
    ds_read_b64 v[236:237], v236 offset:0
    v_mfma_f32_32x32x16_bf16 v[132:147], v[52:55], v[116:119], v[132:147]
    s_waitcnt lgkmcnt(14)
    ds_read_b64 v[246:247], v244 offset:16
    s_waitcnt lgkmcnt(8)
    ds_read_b64 v[244:245], v244 offset:0
    v_or_b32_sdwa v27, v24, v196 dst_sel:DWORD dst_unused:UNUSED_PAD src0_sel:DWORD src1_sel:BYTE_1
    v_or_b32_sdwa v28, v24, v196 dst_sel:DWORD dst_unused:UNUSED_PAD src0_sel:DWORD src1_sel:BYTE_2
    v_or_b32_sdwa v29, v24, v196 dst_sel:DWORD dst_unused:UNUSED_PAD src0_sel:DWORD src1_sel:BYTE_3
    v_or_b32_sdwa v30, v24, v197 dst_sel:DWORD dst_unused:UNUSED_PAD src0_sel:DWORD src1_sel:BYTE_0
    v_or_b32_sdwa v31, v24, v197 dst_sel:DWORD dst_unused:UNUSED_PAD src0_sel:DWORD src1_sel:BYTE_1
    v_or_b32_sdwa v32, v24, v197 dst_sel:DWORD dst_unused:UNUSED_PAD src0_sel:DWORD src1_sel:BYTE_2
    v_mfma_f32_32x32x16_bf16 v[132:147], v[56:59], v[120:123], v[132:147]
    v_or_b32_sdwa v33, v24, v197 dst_sel:DWORD dst_unused:UNUSED_PAD src0_sel:DWORD src1_sel:BYTE_3
    v_or_b32_sdwa v34, v24, v198 dst_sel:DWORD dst_unused:UNUSED_PAD src0_sel:DWORD src1_sel:BYTE_0
    v_or_b32_sdwa v35, v24, v198 dst_sel:DWORD dst_unused:UNUSED_PAD src0_sel:DWORD src1_sel:BYTE_1
    v_readfirstlane_b32 s29, v199
    s_cmp_le_u32 s29, 176
    s_cselect_b64 vcc, -1, 0
    s_add_u32 s29, s29, 31
    v_mfma_f32_32x32x16_bf16 v[132:147], v[60:63], v[124:127], v[132:147]
    s_lshr_b32 s29, s29, 5
    s_max_u32 s29, s29, 2
    s_lshl_b32 s34, s29, 9
    s_sub_u32 s34, s34, 1024
    v_add_u32 v16, s34, v22
    v_mfma_f32_32x32x16_bf16 v[132:147], v[64:67], v[128:131], v[132:147]
    s_waitcnt lgkmcnt(0)
    s_barrier
    ds_read_b128 v[100:103], v21 offset:0
    ds_read_b128 v[104:107], v21 offset:256
    ds_read_b128 v[108:111], v21 offset:512
    ds_read_b128 v[112:115], v21 offset:768
    ds_read_b64_tr_b16 v[84:85], v8 offset:49152
    ds_read_b64_tr_b16 v[86:87], v8 offset:49408
    ds_read_b128 v[116:119], v21 offset:32
    ds_read_b64_tr_b16 v[88:89], v8 offset:50176
    ds_read_b64_tr_b16 v[90:91], v8 offset:50432
    ds_read_b128 v[120:123], v21 offset:288
    s_waitcnt lgkmcnt(9)
    v_mfma_f32_32x32x16_bf16 v[132:147], v[68:71], v[100:103], v[132:147]
    s_waitcnt lgkmcnt(8)
    ds_read_b64_tr_b16 v[92:93], v8 offset:57344
    ds_read_b64_tr_b16 v[94:95], v8 offset:57600
    ds_read_b128 v[124:127], v21 offset:544
    v_mfma_f32_32x32x16_bf16 v[132:147], v[72:75], v[104:107], v[132:147]
    s_waitcnt lgkmcnt(10)
    ds_read_b64_tr_b16 v[96:97], v8 offset:58368
    ds_read_b64_tr_b16 v[98:99], v8 offset:58624
    ds_read_b128 v[128:131], v21 offset:800
    ds_read_b128 v[164:167], v27 offset:0
    v_mfma_f32_32x32x16_bf16 v[132:147], v[76:79], v[108:111], v[132:147]
    s_waitcnt lgkmcnt(13)
    ds_read_b128 v[100:103], v17 offset:8320
    ds_read_b128 v[168:171], v27 offset:512
    v_mfma_f32_32x32x16_bf16 v[132:147], v[80:83], v[112:115], v[132:147]
    s_waitcnt lgkmcnt(12)
    ds_read_b128 v[104:107], v17 offset:8352
    ds_read_b128 v[172:175], v27 offset:1024
    v_mfma_f32_32x32x16_bf16 v[132:147], v[84:87], v[116:119], v[132:147]
    s_waitcnt lgkmcnt(11)
    ds_read_b128 v[108:111], v18 offset:8320
    s_branch L_cmain
.p2align 12
L_touchD:
    s_branch L_cons
    s_nop 0
L_cmain:
    ds_read_b128 v[176:179], v27 offset:1536
    v_mfma_f32_32x32x16_bf16 v[132:147], v[88:91], v[120:123], v[132:147]
    s_waitcnt lgkmcnt(10)
    ds_read_b128 v[112:115], v18 offset:8352
    v_mfma_f32_32x32x16_bf16 v[132:147], v[92:95], v[124:127], v[132:147]
    s_waitcnt lgkmcnt(8)
    ds_read_b128 v[116:119], v19 offset:8320
    v_mfma_f32_32x32x16_bf16 v[148:163], v[96:99], v[128:131], v[132:147]
    s_waitcnt lgkmcnt(2)
    ds_read_b128 v[120:123], v19 offset:8352
    v_mfma_f32_32x32x16_bf16 v[132:147], v[36:39], v[100:103], v[164:179]
    ds_read_b128 v[124:127], v20 offset:8320
    s_nop 2
    v_mfma_f32_32x32x16_bf16 v[132:147], v[40:43], v[104:107], v[132:147]
    s_waitcnt lgkmcnt(3)
    ds_read_b128 v[128:131], v20 offset:8352
    v_mfma_f32_32x32x16_bf16 v[132:147], v[44:47], v[108:111], v[132:147]
    s_barrier
    ds_read_b128 v[100:103], v21 offset:8320
    v_exp_f32 v228, v148
    v_exp_f32 v229, v149
    v_exp_f32 v230, v150
    v_mfma_f32_32x32x16_bf16 v[132:147], v[48:51], v[112:115], v[132:147]
    s_waitcnt lgkmcnt(4)
    ds_read_b128 v[104:107], v21 offset:8576
    v_cvt_pk_f16_f32 v188, v228, v229
    v_exp_f32 v231, v151
    v_pk_add_f16 v188, v188, v6
    v_mfma_f32_32x32x16_bf16 v[132:147], v[52:55], v[116:119], v[132:147]
    s_waitcnt lgkmcnt(4)
    ds_read_b128 v[108:111], v21 offset:8832
    v_exp_f32 v232, v152
    v_cvt_pk_f16_f32 v189, v230, v231
    v_rcp_f16 v180, v188
    v_mfma_f32_32x32x16_bf16 v[132:147], v[56:59], v[120:123], v[132:147]
    s_waitcnt lgkmcnt(4)
    ds_read_b128 v[112:115], v21 offset:9088
    v_exp_f32 v233, v153
    v_pk_add_f16 v189, v189, v6
    v_rcp_f16_sdwa v180, v188 dst_sel:WORD_1 dst_unused:UNUSED_PRESERVE src0_sel:WORD_1
    v_mfma_f32_32x32x16_bf16 v[132:147], v[60:63], v[124:127], v[132:147]
    s_waitcnt lgkmcnt(4)
    ds_read_b128 v[116:119], v21 offset:8352
    ds_read_b128 v[164:167], v28 offset:0
    v_exp_f32 v234, v154
    v_cvt_pk_f16_f32 v190, v232, v233
    v_rcp_f16 v181, v189
    v_mfma_f32_32x32x16_bf16 v[132:147], v[64:67], v[128:131], v[132:147]
    s_waitcnt lgkmcnt(5)
    ds_read_b128 v[120:123], v21 offset:8608
    ds_read_b128 v[168:171], v28 offset:512
    v_exp_f32 v235, v155
    v_pk_add_f16 v190, v190, v6
    v_rcp_f16_sdwa v181, v189 dst_sel:WORD_1 dst_unused:UNUSED_PRESERVE src0_sel:WORD_1
    v_mfma_f32_32x32x16_bf16 v[132:147], v[68:71], v[100:103], v[132:147]
    s_waitcnt lgkmcnt(6)
    ds_read_b128 v[124:127], v21 offset:8864
    ds_read_b128 v[172:175], v28 offset:1024
    v_exp_f32 v228, v156
    v_cvt_pk_f16_f32 v191, v234, v235
    v_rcp_f16 v182, v190
    v_mfma_f32_32x32x16_bf16 v[132:147], v[72:75], v[104:107], v[132:147]
    s_waitcnt lgkmcnt(7)
    ds_read_b128 v[128:131], v21 offset:9120
    ds_read_b128 v[176:179], v28 offset:1536
    v_exp_f32 v229, v157
    v_pk_add_f16 v191, v191, v6
    v_rcp_f16_sdwa v182, v190 dst_sel:WORD_1 dst_unused:UNUSED_PRESERVE src0_sel:WORD_1
    v_mfma_f32_32x32x16_bf16 v[132:147], v[76:79], v[108:111], v[132:147]
    s_waitcnt lgkmcnt(8)
    ds_read_b128 v[100:103], v17 offset:16640
    v_exp_f32 v230, v158
    v_cvt_pk_f16_f32 v188, v228, v229
    v_rcp_f16 v183, v191
    v_mfma_f32_32x32x16_bf16 v[132:147], v[80:83], v[112:115], v[132:147]
    s_waitcnt lgkmcnt(6)
    ds_read_b128 v[104:107], v17 offset:16672
    v_exp_f32 v231, v159
    v_pk_add_f16 v188, v188, v6
    v_rcp_f16_sdwa v183, v191 dst_sel:WORD_1 dst_unused:UNUSED_PRESERVE src0_sel:WORD_1
    v_mfma_f32_32x32x16_bf16 v[132:147], v[84:87], v[116:119], v[132:147]
    s_cmp_eq_u32 s29, 2
    ds_read_b128 v[108:111], v18 offset:16640
    v_exp_f32 v232, v160
    v_cvt_pk_f16_f32 v189, v230, v231
    v_rcp_f16 v184, v188
    v_mfma_f32_16x16x32_f16 v[192:195], v[236:239], v[180:183], 0
    v_exp_f32 v233, v161
    v_mfma_f32_32x32x16_bf16 v[132:147], v[88:91], v[120:123], v[132:147]
    s_waitcnt lgkmcnt(6)
    ds_read_b128 v[112:115], v18 offset:16672
    v_pk_add_f16 v189, v189, v6
    v_rcp_f16_sdwa v184, v188 dst_sel:WORD_1 dst_unused:UNUSED_PRESERVE src0_sel:WORD_1
    v_exp_f32 v234, v162
    v_mfma_f32_32x32x16_bf16 v[132:147], v[92:95], v[124:127], v[132:147]
    s_waitcnt lgkmcnt(3)
    ds_read_b128 v[116:119], v19 offset:16640
    v_cvt_pk_f16_f32 v190, v232, v233
    v_rcp_f16 v185, v189
    v_exp_f32 v235, v163
    v_mfma_f32_32x32x16_bf16 v[148:163], v[96:99], v[128:131], v[132:147]
    s_cbranch_scc1 L_drain
    ds_read_b128 v[120:123], v19 offset:16672
    v_pk_add_f16 v190, v190, v6
    v_rcp_f16_sdwa v185, v189 dst_sel:WORD_1 dst_unused:UNUSED_PRESERVE src0_sel:WORD_1
    v_cvt_pk_f16_f32 v191, v234, v235
    v_mfma_f32_32x32x16_bf16 v[132:147], v[36:39], v[100:103], v[164:179]
    s_waitcnt lgkmcnt(4)
    ds_read_b128 v[124:127], v20 offset:16640
    v_rcp_f16 v186, v190
    v_pk_add_f16 v191, v191, v6
    v_rcp_f16 v187, v191
    v_mfma_f32_32x32x16_bf16 v[132:147], v[40:43], v[104:107], v[132:147]
    s_waitcnt lgkmcnt(3)
    ds_read_b128 v[128:131], v20 offset:16672
    v_rcp_f16_sdwa v186, v190 dst_sel:WORD_1 dst_unused:UNUSED_PRESERVE src0_sel:WORD_1
    v_rcp_f16_sdwa v187, v191 dst_sel:WORD_1 dst_unused:UNUSED_PRESERVE src0_sel:WORD_1
    v_mfma_f32_32x32x16_bf16 v[132:147], v[44:47], v[108:111], v[132:147]
    s_barrier
    ds_read_b128 v[100:103], v21 offset:0
    v_exp_f32 v228, v148
    v_exp_f32 v229, v149
    v_mfma_f32_16x16x32_f16 v[192:195], v[240:243], v[184:187], v[192:195]
    v_exp_f32 v230, v150
    v_mfma_f32_32x32x16_bf16 v[132:147], v[48:51], v[112:115], v[132:147]
    s_waitcnt lgkmcnt(4)
    ds_read_b128 v[104:107], v21 offset:256
    v_cvt_pk_f16_f32 v188, v228, v229
    v_exp_f32 v231, v151
    v_pk_add_f16 v188, v188, v6
    v_mfma_f32_32x32x16_bf16 v[132:147], v[52:55], v[116:119], v[132:147]
    s_waitcnt lgkmcnt(4)
    ds_read_b128 v[108:111], v21 offset:512
    v_exp_f32 v232, v152
    v_cvt_pk_f16_f32 v189, v230, v231
    v_rcp_f16 v180, v188
    v_mfma_f32_32x32x16_bf16 v[132:147], v[56:59], v[120:123], v[132:147]
    s_waitcnt lgkmcnt(4)
    ds_read_b128 v[112:115], v21 offset:768
    ds_write_b32 v22, v192 offset:0
    v_exp_f32 v233, v153
    v_pk_add_f16 v189, v189, v6
    v_rcp_f16_sdwa v180, v188 dst_sel:WORD_1 dst_unused:UNUSED_PRESERVE src0_sel:WORD_1
    v_mfma_f32_32x32x16_bf16 v[132:147], v[60:63], v[124:127], v[132:147]
    s_waitcnt lgkmcnt(5)
    ds_read_b128 v[116:119], v21 offset:32
    ds_read_b128 v[164:167], v29 offset:0
    v_exp_f32 v234, v154
    v_cvt_pk_f16_f32 v190, v232, v233
    v_rcp_f16 v181, v189
    v_mfma_f32_32x32x16_bf16 v[132:147], v[64:67], v[128:131], v[132:147]
    s_waitcnt lgkmcnt(6)
    ds_read_b128 v[120:123], v21 offset:288
    ds_read_b128 v[168:171], v29 offset:512
    v_exp_f32 v235, v155
    v_pk_add_f16 v190, v190, v6
    v_rcp_f16_sdwa v181, v189 dst_sel:WORD_1 dst_unused:UNUSED_PRESERVE src0_sel:WORD_1
    v_mfma_f32_32x32x16_bf16 v[132:147], v[68:71], v[100:103], v[132:147]
    s_waitcnt lgkmcnt(7)
    ds_read_b128 v[124:127], v21 offset:544
    ds_read_b128 v[172:175], v29 offset:1024
    v_exp_f32 v228, v156
    v_cvt_pk_f16_f32 v191, v234, v235
    v_rcp_f16 v182, v190
    v_mfma_f32_32x32x16_bf16 v[132:147], v[72:75], v[104:107], v[132:147]
    s_waitcnt lgkmcnt(8)
    ds_read_b128 v[128:131], v21 offset:800
    ds_read_b128 v[176:179], v29 offset:1536
    v_exp_f32 v229, v157
    v_pk_add_f16 v191, v191, v6
    v_rcp_f16_sdwa v182, v190 dst_sel:WORD_1 dst_unused:UNUSED_PRESERVE src0_sel:WORD_1
    v_mfma_f32_32x32x16_bf16 v[132:147], v[76:79], v[108:111], v[132:147]
    s_waitcnt lgkmcnt(9)
    ds_read_b128 v[100:103], v17 offset:24960
    v_exp_f32 v230, v158
    v_cvt_pk_f16_f32 v188, v228, v229
    v_rcp_f16 v183, v191
    v_mfma_f32_32x32x16_bf16 v[132:147], v[80:83], v[112:115], v[132:147]
    s_waitcnt lgkmcnt(6)
    ds_read_b128 v[104:107], v17 offset:24992
    v_exp_f32 v231, v159
    v_pk_add_f16 v188, v188, v6
    v_rcp_f16_sdwa v183, v191 dst_sel:WORD_1 dst_unused:UNUSED_PRESERVE src0_sel:WORD_1
    v_mfma_f32_32x32x16_bf16 v[132:147], v[84:87], v[116:119], v[132:147]
    s_cmp_eq_u32 s29, 3
    ds_read_b128 v[108:111], v18 offset:24960
    v_exp_f32 v232, v160
    v_cvt_pk_f16_f32 v189, v230, v231
    v_rcp_f16 v184, v188
    v_mfma_f32_16x16x32_f16 v[192:195], v[236:239], v[180:183], 0
    v_exp_f32 v233, v161
    v_mfma_f32_32x32x16_bf16 v[132:147], v[88:91], v[120:123], v[132:147]
    s_waitcnt lgkmcnt(6)
    ds_read_b128 v[112:115], v18 offset:24992
    v_pk_add_f16 v189, v189, v6
    v_rcp_f16_sdwa v184, v188 dst_sel:WORD_1 dst_unused:UNUSED_PRESERVE src0_sel:WORD_1
    v_exp_f32 v234, v162
    v_mfma_f32_32x32x16_bf16 v[132:147], v[92:95], v[124:127], v[132:147]
    s_waitcnt lgkmcnt(3)
    ds_read_b128 v[116:119], v19 offset:24960
    v_cvt_pk_f16_f32 v190, v232, v233
    v_rcp_f16 v185, v189
    v_exp_f32 v235, v163
    v_mfma_f32_32x32x16_bf16 v[148:163], v[96:99], v[128:131], v[132:147]
    s_cbranch_scc1 L_drain
    ds_read_b128 v[120:123], v19 offset:24992
    v_pk_add_f16 v190, v190, v6
    v_rcp_f16_sdwa v185, v189 dst_sel:WORD_1 dst_unused:UNUSED_PRESERVE src0_sel:WORD_1
    v_cvt_pk_f16_f32 v191, v234, v235
    v_mfma_f32_32x32x16_bf16 v[132:147], v[36:39], v[100:103], v[164:179]
    s_waitcnt lgkmcnt(4)
    ds_read_b128 v[124:127], v20 offset:24960
    v_rcp_f16 v186, v190
    v_pk_add_f16 v191, v191, v6
    v_rcp_f16 v187, v191
    v_mfma_f32_32x32x16_bf16 v[132:147], v[40:43], v[104:107], v[132:147]
    s_waitcnt lgkmcnt(3)
    ds_read_b128 v[128:131], v20 offset:24992
    v_rcp_f16_sdwa v186, v190 dst_sel:WORD_1 dst_unused:UNUSED_PRESERVE src0_sel:WORD_1
    v_rcp_f16_sdwa v187, v191 dst_sel:WORD_1 dst_unused:UNUSED_PRESERVE src0_sel:WORD_1
    v_mfma_f32_32x32x16_bf16 v[132:147], v[44:47], v[108:111], v[132:147]
    s_barrier
    ds_read_b128 v[100:103], v21 offset:8320
    v_exp_f32 v228, v148
    v_exp_f32 v229, v149
    v_mfma_f32_16x16x32_f16 v[192:195], v[240:243], v[184:187], v[192:195]
    v_exp_f32 v230, v150
    v_mfma_f32_32x32x16_bf16 v[132:147], v[48:51], v[112:115], v[132:147]
    s_waitcnt lgkmcnt(4)
    ds_read_b128 v[104:107], v21 offset:8576
    v_cvt_pk_f16_f32 v188, v228, v229
    v_exp_f32 v231, v151
    v_pk_add_f16 v188, v188, v6
    v_mfma_f32_32x32x16_bf16 v[132:147], v[52:55], v[116:119], v[132:147]
    s_waitcnt lgkmcnt(4)
    ds_read_b128 v[108:111], v21 offset:8832
    v_exp_f32 v232, v152
    v_cvt_pk_f16_f32 v189, v230, v231
    v_rcp_f16 v180, v188
    v_mfma_f32_32x32x16_bf16 v[132:147], v[56:59], v[120:123], v[132:147]
    s_waitcnt lgkmcnt(4)
    ds_read_b128 v[112:115], v21 offset:9088
    ds_write_b32 v22, v192 offset:512
    v_exp_f32 v233, v153
    v_pk_add_f16 v189, v189, v6
    v_rcp_f16_sdwa v180, v188 dst_sel:WORD_1 dst_unused:UNUSED_PRESERVE src0_sel:WORD_1
    v_mfma_f32_32x32x16_bf16 v[132:147], v[60:63], v[124:127], v[132:147]
    s_waitcnt lgkmcnt(5)
    ds_read_b128 v[116:119], v21 offset:8352
    ds_read_b128 v[164:167], v30 offset:0
    v_exp_f32 v234, v154
    v_cvt_pk_f16_f32 v190, v232, v233
    v_rcp_f16 v181, v189
    v_mfma_f32_32x32x16_bf16 v[132:147], v[64:67], v[128:131], v[132:147]
    s_waitcnt lgkmcnt(6)
    ds_read_b128 v[120:123], v21 offset:8608
    ds_read_b128 v[168:171], v30 offset:512
    v_exp_f32 v235, v155
    v_pk_add_f16 v190, v190, v6
    v_rcp_f16_sdwa v181, v189 dst_sel:WORD_1 dst_unused:UNUSED_PRESERVE src0_sel:WORD_1
    v_mfma_f32_32x32x16_bf16 v[132:147], v[68:71], v[100:103], v[132:147]
    s_waitcnt lgkmcnt(7)
    ds_read_b128 v[124:127], v21 offset:8864
    ds_read_b128 v[172:175], v30 offset:1024
    v_exp_f32 v228, v156
    v_cvt_pk_f16_f32 v191, v234, v235
    v_rcp_f16 v182, v190
    v_mfma_f32_32x32x16_bf16 v[132:147], v[72:75], v[104:107], v[132:147]
    s_waitcnt lgkmcnt(8)
    ds_read_b128 v[128:131], v21 offset:9120
    ds_read_b128 v[176:179], v30 offset:1536
    v_exp_f32 v229, v157
    v_pk_add_f16 v191, v191, v6
    v_rcp_f16_sdwa v182, v190 dst_sel:WORD_1 dst_unused:UNUSED_PRESERVE src0_sel:WORD_1
    v_mfma_f32_32x32x16_bf16 v[132:147], v[76:79], v[108:111], v[132:147]
    s_waitcnt lgkmcnt(9)
    ds_read_b128 v[100:103], v17 offset:33280
    v_exp_f32 v230, v158
    v_cvt_pk_f16_f32 v188, v228, v229
    v_rcp_f16 v183, v191
    v_mfma_f32_32x32x16_bf16 v[132:147], v[80:83], v[112:115], v[132:147]
    s_waitcnt lgkmcnt(6)
    ds_read_b128 v[104:107], v17 offset:33312
    v_exp_f32 v231, v159
    v_pk_add_f16 v188, v188, v6
    v_rcp_f16_sdwa v183, v191 dst_sel:WORD_1 dst_unused:UNUSED_PRESERVE src0_sel:WORD_1
    v_mfma_f32_32x32x16_bf16 v[132:147], v[84:87], v[116:119], v[132:147]
    s_cmp_eq_u32 s29, 4
    ds_read_b128 v[108:111], v18 offset:33280
    v_exp_f32 v232, v160
    v_cvt_pk_f16_f32 v189, v230, v231
    v_rcp_f16 v184, v188
    v_mfma_f32_16x16x32_f16 v[192:195], v[236:239], v[180:183], 0
    v_exp_f32 v233, v161
    v_mfma_f32_32x32x16_bf16 v[132:147], v[88:91], v[120:123], v[132:147]
    s_waitcnt lgkmcnt(6)
    ds_read_b128 v[112:115], v18 offset:33312
    v_pk_add_f16 v189, v189, v6
    v_rcp_f16_sdwa v184, v188 dst_sel:WORD_1 dst_unused:UNUSED_PRESERVE src0_sel:WORD_1
    v_exp_f32 v234, v162
    v_mfma_f32_32x32x16_bf16 v[132:147], v[92:95], v[124:127], v[132:147]
    s_waitcnt lgkmcnt(3)
    ds_read_b128 v[116:119], v19 offset:33280
    v_cvt_pk_f16_f32 v190, v232, v233
    v_rcp_f16 v185, v189
    v_exp_f32 v235, v163
    v_mfma_f32_32x32x16_bf16 v[148:163], v[96:99], v[128:131], v[132:147]
    s_cbranch_scc1 L_drain
    ds_read_b128 v[120:123], v19 offset:33312
    v_pk_add_f16 v190, v190, v6
    v_rcp_f16_sdwa v185, v189 dst_sel:WORD_1 dst_unused:UNUSED_PRESERVE src0_sel:WORD_1
    v_cvt_pk_f16_f32 v191, v234, v235
    v_mfma_f32_32x32x16_bf16 v[132:147], v[36:39], v[100:103], v[164:179]
    s_waitcnt lgkmcnt(4)
    ds_read_b128 v[124:127], v20 offset:33280
    v_rcp_f16 v186, v190
    v_pk_add_f16 v191, v191, v6
    v_rcp_f16 v187, v191
    v_mfma_f32_32x32x16_bf16 v[132:147], v[40:43], v[104:107], v[132:147]
    s_waitcnt lgkmcnt(3)
    ds_read_b128 v[128:131], v20 offset:33312
    v_rcp_f16_sdwa v186, v190 dst_sel:WORD_1 dst_unused:UNUSED_PRESERVE src0_sel:WORD_1
    v_rcp_f16_sdwa v187, v191 dst_sel:WORD_1 dst_unused:UNUSED_PRESERVE src0_sel:WORD_1
    v_mfma_f32_32x32x16_bf16 v[132:147], v[44:47], v[108:111], v[132:147]
    s_barrier
    ds_read_b128 v[100:103], v21 offset:0
    v_exp_f32 v228, v148
    v_exp_f32 v229, v149
    v_mfma_f32_16x16x32_f16 v[192:195], v[240:243], v[184:187], v[192:195]
    v_exp_f32 v230, v150
    v_mfma_f32_32x32x16_bf16 v[132:147], v[48:51], v[112:115], v[132:147]
    s_waitcnt lgkmcnt(4)
    ds_read_b128 v[104:107], v21 offset:256
    v_cvt_pk_f16_f32 v188, v228, v229
    v_exp_f32 v231, v151
    v_pk_add_f16 v188, v188, v6
    v_mfma_f32_32x32x16_bf16 v[132:147], v[52:55], v[116:119], v[132:147]
    s_waitcnt lgkmcnt(4)
    ds_read_b128 v[108:111], v21 offset:512
    v_exp_f32 v232, v152
    v_cvt_pk_f16_f32 v189, v230, v231
    v_rcp_f16 v180, v188
    v_mfma_f32_32x32x16_bf16 v[132:147], v[56:59], v[120:123], v[132:147]
    s_waitcnt lgkmcnt(4)
    ds_read_b128 v[112:115], v21 offset:768
    ds_write_b32 v22, v192 offset:1024
    v_exp_f32 v233, v153
    v_pk_add_f16 v189, v189, v6
    v_rcp_f16_sdwa v180, v188 dst_sel:WORD_1 dst_unused:UNUSED_PRESERVE src0_sel:WORD_1
    v_mfma_f32_32x32x16_bf16 v[132:147], v[60:63], v[124:127], v[132:147]
    s_waitcnt lgkmcnt(5)
    ds_read_b128 v[116:119], v21 offset:32
    ds_read_b128 v[164:167], v31 offset:0
    v_exp_f32 v234, v154
    v_cvt_pk_f16_f32 v190, v232, v233
    v_rcp_f16 v181, v189
    v_mfma_f32_32x32x16_bf16 v[132:147], v[64:67], v[128:131], v[132:147]
    s_waitcnt lgkmcnt(6)
    ds_read_b128 v[120:123], v21 offset:288
    ds_read_b128 v[168:171], v31 offset:512
    v_exp_f32 v235, v155
    v_pk_add_f16 v190, v190, v6
    v_rcp_f16_sdwa v181, v189 dst_sel:WORD_1 dst_unused:UNUSED_PRESERVE src0_sel:WORD_1
    v_mfma_f32_32x32x16_bf16 v[132:147], v[68:71], v[100:103], v[132:147]
    s_waitcnt lgkmcnt(7)
    ds_read_b128 v[124:127], v21 offset:544
    ds_read_b128 v[172:175], v31 offset:1024
    v_exp_f32 v228, v156
    v_cvt_pk_f16_f32 v191, v234, v235
    v_rcp_f16 v182, v190
    v_mfma_f32_32x32x16_bf16 v[132:147], v[72:75], v[104:107], v[132:147]
    s_waitcnt lgkmcnt(8)
    ds_read_b128 v[128:131], v21 offset:800
    ds_read_b128 v[176:179], v31 offset:1536
    v_exp_f32 v229, v157
    v_pk_add_f16 v191, v191, v6
    v_rcp_f16_sdwa v182, v190 dst_sel:WORD_1 dst_unused:UNUSED_PRESERVE src0_sel:WORD_1
    v_mfma_f32_32x32x16_bf16 v[132:147], v[76:79], v[108:111], v[132:147]
    s_waitcnt lgkmcnt(9)
    ds_read_b128 v[100:103], v17 offset:41600
    v_exp_f32 v230, v158
    v_cvt_pk_f16_f32 v188, v228, v229
    v_rcp_f16 v183, v191
    v_mfma_f32_32x32x16_bf16 v[132:147], v[80:83], v[112:115], v[132:147]
    s_waitcnt lgkmcnt(6)
    ds_read_b128 v[104:107], v17 offset:41632
    v_exp_f32 v231, v159
    v_pk_add_f16 v188, v188, v6
    v_rcp_f16_sdwa v183, v191 dst_sel:WORD_1 dst_unused:UNUSED_PRESERVE src0_sel:WORD_1
    v_mfma_f32_32x32x16_bf16 v[132:147], v[84:87], v[116:119], v[132:147]
    s_cmp_eq_u32 s29, 5
    ds_read_b128 v[108:111], v18 offset:41600
    v_exp_f32 v232, v160
    v_cvt_pk_f16_f32 v189, v230, v231
    v_rcp_f16 v184, v188
    v_mfma_f32_16x16x32_f16 v[192:195], v[236:239], v[180:183], 0
    v_exp_f32 v233, v161
    v_mfma_f32_32x32x16_bf16 v[132:147], v[88:91], v[120:123], v[132:147]
    s_waitcnt lgkmcnt(6)
    ds_read_b128 v[112:115], v18 offset:41632
    v_pk_add_f16 v189, v189, v6
    v_rcp_f16_sdwa v184, v188 dst_sel:WORD_1 dst_unused:UNUSED_PRESERVE src0_sel:WORD_1
    v_exp_f32 v234, v162
    v_mfma_f32_32x32x16_bf16 v[132:147], v[92:95], v[124:127], v[132:147]
    s_waitcnt lgkmcnt(3)
    ds_read_b128 v[116:119], v19 offset:41600
    v_cvt_pk_f16_f32 v190, v232, v233
    v_rcp_f16 v185, v189
    v_exp_f32 v235, v163
    v_mfma_f32_32x32x16_bf16 v[148:163], v[96:99], v[128:131], v[132:147]
    s_cbranch_scc1 L_drain
    ds_read_b128 v[120:123], v19 offset:41632
    v_pk_add_f16 v190, v190, v6
    v_rcp_f16_sdwa v185, v189 dst_sel:WORD_1 dst_unused:UNUSED_PRESERVE src0_sel:WORD_1
    v_cvt_pk_f16_f32 v191, v234, v235
    s_cmp_gt_u32 s29, 6
    s_cbranch_scc1 L_cmore
    v_mfma_f32_32x32x16_bf16 v[132:147], v[36:39], v[100:103], v[164:179]
    s_waitcnt lgkmcnt(4)
    ds_read_b128 v[124:127], v20 offset:41600
    v_rcp_f16 v186, v190
    v_pk_add_f16 v191, v191, v6
    v_rcp_f16 v187, v191
    v_mfma_f32_32x32x16_bf16 v[132:147], v[40:43], v[104:107], v[132:147]
    s_waitcnt lgkmcnt(3)
    ds_read_b128 v[128:131], v20 offset:41632
    v_rcp_f16_sdwa v186, v190 dst_sel:WORD_1 dst_unused:UNUSED_PRESERVE src0_sel:WORD_1
    v_rcp_f16_sdwa v187, v191 dst_sel:WORD_1 dst_unused:UNUSED_PRESERVE src0_sel:WORD_1
    v_mfma_f32_32x32x16_bf16 v[132:147], v[44:47], v[108:111], v[132:147]
    s_barrier
    ds_read_b128 v[100:103], v21 offset:8320
    v_exp_f32 v228, v148
    v_mfma_f32_16x16x32_f16 v[192:195], v[240:243], v[184:187], v[192:195]
    v_exp_f32 v229, v149
    v_mfma_f32_32x32x16_bf16 v[132:147], v[48:51], v[112:115], v[132:147]
    s_waitcnt lgkmcnt(4)
    ds_read_b128 v[104:107], v21 offset:8576
    v_exp_f32 v230, v150
    v_cvt_pk_f16_f32 v188, v228, v229
    v_exp_f32 v231, v151
    v_mfma_f32_32x32x16_bf16 v[132:147], v[52:55], v[116:119], v[132:147]
    s_waitcnt lgkmcnt(4)
    ds_read_b128 v[108:111], v21 offset:8832
    v_pk_add_f16 v188, v188, v6
    v_exp_f32 v232, v152
    v_cvt_pk_f16_f32 v189, v230, v231
    v_mfma_f32_32x32x16_bf16 v[132:147], v[56:59], v[120:123], v[132:147]
    s_waitcnt lgkmcnt(4)
    ds_read_b128 v[112:115], v21 offset:9088
    ds_write_b32 v22, v192 offset:1536
    v_rcp_f16 v180, v188
    v_exp_f32 v233, v153
    v_mfma_f32_32x32x16_bf16 v[132:147], v[60:63], v[124:127], v[132:147]
    s_waitcnt lgkmcnt(5)
    ds_read_b128 v[116:119], v21 offset:8352
    v_pk_add_f16 v189, v189, v6
    v_rcp_f16_sdwa v180, v188 dst_sel:WORD_1 dst_unused:UNUSED_PRESERVE src0_sel:WORD_1
    v_exp_f32 v234, v154
    v_mfma_f32_32x32x16_bf16 v[132:147], v[64:67], v[128:131], v[132:147]
    s_waitcnt lgkmcnt(5)
    ds_read_b128 v[120:123], v21 offset:8608
    v_cvt_pk_f16_f32 v190, v232, v233
    v_rcp_f16 v181, v189
    v_exp_f32 v235, v155
    v_mfma_f32_32x32x16_bf16 v[132:147], v[68:71], v[100:103], v[132:147]
    s_waitcnt lgkmcnt(5)
    ds_read_b128 v[124:127], v21 offset:8864
    v_pk_add_f16 v190, v190, v6
    v_rcp_f16_sdwa v181, v189 dst_sel:WORD_1 dst_unused:UNUSED_PRESERVE src0_sel:WORD_1
    v_exp_f32 v228, v156
    v_mfma_f32_32x32x16_bf16 v[132:147], v[72:75], v[104:107], v[132:147]
    s_waitcnt lgkmcnt(5)
    ds_read_b128 v[128:131], v21 offset:9120
    v_cvt_pk_f16_f32 v191, v234, v235
    v_rcp_f16 v182, v190
    v_exp_f32 v229, v157
    v_mfma_f32_32x32x16_bf16 v[132:147], v[76:79], v[108:111], v[132:147]
    s_waitcnt lgkmcnt(5)
    v_pk_add_f16 v191, v191, v6
    v_rcp_f16_sdwa v182, v190 dst_sel:WORD_1 dst_unused:UNUSED_PRESERVE src0_sel:WORD_1
    v_exp_f32 v230, v158
    v_mfma_f32_32x32x16_bf16 v[132:147], v[80:83], v[112:115], v[132:147]
    s_waitcnt lgkmcnt(3)
    v_cvt_pk_f16_f32 v188, v228, v229
    v_rcp_f16 v183, v191
    v_exp_f32 v231, v159
    v_mfma_f32_32x32x16_bf16 v[132:147], v[84:87], v[116:119], v[132:147]
    s_waitcnt lgkmcnt(2)
    v_pk_add_f16 v188, v188, v6
    v_rcp_f16_sdwa v183, v191 dst_sel:WORD_1 dst_unused:UNUSED_PRESERVE src0_sel:WORD_1
    v_exp_f32 v232, v160
    v_cvt_pk_f16_f32 v189, v230, v231
    v_mfma_f32_16x16x32_f16 v[192:195], v[236:239], v[180:183], 0
    v_rcp_f16 v184, v188
    v_mfma_f32_32x32x16_bf16 v[132:147], v[88:91], v[120:123], v[132:147]
    s_waitcnt lgkmcnt(1)
    v_exp_f32 v233, v161
    v_pk_add_f16 v189, v189, v6
    v_rcp_f16_sdwa v184, v188 dst_sel:WORD_1 dst_unused:UNUSED_PRESERVE src0_sel:WORD_1
    v_mfma_f32_32x32x16_bf16 v[132:147], v[92:95], v[124:127], v[132:147]
    s_waitcnt lgkmcnt(0)
    v_exp_f32 v234, v162
    v_cvt_pk_f16_f32 v190, v232, v233
    v_rcp_f16 v185, v189
    v_exp_f32 v235, v163
    v_mfma_f32_32x32x16_bf16 v[148:163], v[96:99], v[128:131], v[132:147]
    s_cbranch_vccz L_drain
    s_barrier
    v_pk_add_f16 v190, v190, v6
    v_rcp_f16_sdwa v185, v189 dst_sel:WORD_1 dst_unused:UNUSED_PRESERVE src0_sel:WORD_1
    v_cvt_pk_f16_f32 v191, v234, v235
    v_rcp_f16 v186, v190
    v_pk_add_f16 v191, v191, v6
    v_rcp_f16 v187, v191
    v_rcp_f16_sdwa v186, v190 dst_sel:WORD_1 dst_unused:UNUSED_PRESERVE src0_sel:WORD_1
    v_rcp_f16_sdwa v187, v191 dst_sel:WORD_1 dst_unused:UNUSED_PRESERVE src0_sel:WORD_1
    s_nop 1
    v_mfma_f32_16x16x32_f16 v[192:195], v[240:243], v[184:187], v[192:195]
    v_permlane16_swap_b32 v148, v156
    v_permlane16_swap_b32 v149, v157
    v_permlane16_swap_b32 v150, v158
    v_permlane16_swap_b32 v151, v159
    v_permlane16_swap_b32 v152, v160
    v_permlane16_swap_b32 v153, v161
    v_permlane16_swap_b32 v154, v162
    v_permlane16_swap_b32 v155, v163
    v_exp_f32 v228, v148
    v_exp_f32 v229, v149
    v_exp_f32 v230, v150
    v_cvt_pk_f16_f32 v188, v228, v229
    v_exp_f32 v231, v151
    v_pk_add_f16 v188, v188, v6
    v_exp_f32 v232, v152
    v_cvt_pk_f16_f32 v189, v230, v231
    v_rcp_f16 v180, v188
    v_exp_f32 v233, v153
    v_pk_add_f16 v189, v189, v6
    v_rcp_f16_sdwa v180, v188 dst_sel:WORD_1 dst_unused:UNUSED_PRESERVE src0_sel:WORD_1
    v_exp_f32 v234, v154
    v_cvt_pk_f16_f32 v190, v232, v233
    v_rcp_f16 v181, v189
    v_exp_f32 v235, v155
    v_pk_add_f16 v190, v190, v6
    s_barrier
    v_rcp_f16_sdwa v181, v189 dst_sel:WORD_1 dst_unused:UNUSED_PRESERVE src0_sel:WORD_1
    v_cvt_pk_f16_f32 v191, v234, v235
    v_rcp_f16 v182, v190
    v_pk_add_f16 v191, v191, v6
    v_rcp_f16 v183, v191
    v_rcp_f16_sdwa v182, v190 dst_sel:WORD_1 dst_unused:UNUSED_PRESERVE src0_sel:WORD_1
    v_rcp_f16_sdwa v183, v191 dst_sel:WORD_1 dst_unused:UNUSED_PRESERVE src0_sel:WORD_1
    s_nop 1
    v_mfma_f32_16x16x32_f16 v[132:135], v[244:247], v[180:183], 0
    s_mov_b32 exec_hi, 0
    s_nop 6
    ds_write2st64_b32 v16, v192, v132 offset0:0 offset1:2
    s_waitcnt lgkmcnt(0)
    s_barrier
    s_endpgm
L_drain:
    s_barrier
    v_pk_add_f16 v190, v190, v6
    v_rcp_f16_sdwa v185, v189 dst_sel:WORD_1 dst_unused:UNUSED_PRESERVE src0_sel:WORD_1
    v_cvt_pk_f16_f32 v191, v234, v235
    v_rcp_f16 v186, v190
    v_pk_add_f16 v191, v191, v6
    v_rcp_f16 v187, v191
    v_rcp_f16_sdwa v186, v190 dst_sel:WORD_1 dst_unused:UNUSED_PRESERVE src0_sel:WORD_1
    v_rcp_f16_sdwa v187, v191 dst_sel:WORD_1 dst_unused:UNUSED_PRESERVE src0_sel:WORD_1
    s_nop 1
    v_mfma_f32_16x16x32_f16 v[192:195], v[240:243], v[184:187], v[192:195]
    v_exp_f32 v228, v148
    v_exp_f32 v229, v149
    v_exp_f32 v230, v150
    v_cvt_pk_f16_f32 v188, v228, v229
    v_exp_f32 v231, v151
    v_pk_add_f16 v188, v188, v6
    v_exp_f32 v232, v152
    v_cvt_pk_f16_f32 v189, v230, v231
    v_rcp_f16 v180, v188
    v_exp_f32 v233, v153
    v_pk_add_f16 v189, v189, v6
    v_rcp_f16_sdwa v180, v188 dst_sel:WORD_1 dst_unused:UNUSED_PRESERVE src0_sel:WORD_1
    v_exp_f32 v234, v154
    v_cvt_pk_f16_f32 v190, v232, v233
    v_rcp_f16 v181, v189
    v_exp_f32 v235, v155
    v_pk_add_f16 v190, v190, v6
    v_rcp_f16_sdwa v181, v189 dst_sel:WORD_1 dst_unused:UNUSED_PRESERVE src0_sel:WORD_1
    v_exp_f32 v228, v156
    v_cvt_pk_f16_f32 v191, v234, v235
    v_rcp_f16 v182, v190
    v_exp_f32 v229, v157
    v_pk_add_f16 v191, v191, v6
    v_rcp_f16_sdwa v182, v190 dst_sel:WORD_1 dst_unused:UNUSED_PRESERVE src0_sel:WORD_1
    v_exp_f32 v230, v158
    v_cvt_pk_f16_f32 v188, v228, v229
    v_rcp_f16 v183, v191
    v_exp_f32 v231, v159
    v_pk_add_f16 v188, v188, v6
    v_rcp_f16_sdwa v183, v191 dst_sel:WORD_1 dst_unused:UNUSED_PRESERVE src0_sel:WORD_1
    v_exp_f32 v232, v160
    v_cvt_pk_f16_f32 v189, v230, v231
    v_mfma_f32_16x16x32_f16 v[132:135], v[236:239], v[180:183], 0
    v_rcp_f16 v184, v188
    v_exp_f32 v233, v161
    v_pk_add_f16 v189, v189, v6
    v_rcp_f16_sdwa v184, v188 dst_sel:WORD_1 dst_unused:UNUSED_PRESERVE src0_sel:WORD_1
    v_exp_f32 v234, v162
    v_cvt_pk_f16_f32 v190, v232, v233
    v_rcp_f16 v185, v189
    v_exp_f32 v235, v163
    v_pk_add_f16 v190, v190, v6
    s_barrier
    v_rcp_f16_sdwa v185, v189 dst_sel:WORD_1 dst_unused:UNUSED_PRESERVE src0_sel:WORD_1
    v_cvt_pk_f16_f32 v191, v234, v235
    v_rcp_f16 v186, v190
    v_pk_add_f16 v191, v191, v6
    v_rcp_f16 v187, v191
    v_rcp_f16_sdwa v186, v190 dst_sel:WORD_1 dst_unused:UNUSED_PRESERVE src0_sel:WORD_1
    v_rcp_f16_sdwa v187, v191 dst_sel:WORD_1 dst_unused:UNUSED_PRESERVE src0_sel:WORD_1
    s_nop 1
    v_mfma_f32_16x16x32_f16 v[132:135], v[240:243], v[184:187], v[132:135]
    s_mov_b32 exec_hi, 0
    s_nop 6
    ds_write2st64_b32 v16, v192, v132 offset0:0 offset1:2
    s_waitcnt lgkmcnt(0)
    s_barrier
    s_endpgm
L_cmore:
    v_mfma_f32_32x32x16_bf16 v[132:147], v[36:39], v[100:103], v[164:179]
    s_waitcnt lgkmcnt(4)
    ds_read_b128 v[124:127], v20 offset:41600
    v_rcp_f16 v186, v190
    v_pk_add_f16 v191, v191, v6
    v_rcp_f16 v187, v191
    v_mfma_f32_32x32x16_bf16 v[132:147], v[40:43], v[104:107], v[132:147]
    s_waitcnt lgkmcnt(3)
    ds_read_b128 v[128:131], v20 offset:41632
    v_rcp_f16_sdwa v186, v190 dst_sel:WORD_1 dst_unused:UNUSED_PRESERVE src0_sel:WORD_1
    v_rcp_f16_sdwa v187, v191 dst_sel:WORD_1 dst_unused:UNUSED_PRESERVE src0_sel:WORD_1
    v_mfma_f32_32x32x16_bf16 v[132:147], v[44:47], v[108:111], v[132:147]
    s_barrier
    ds_read_b128 v[100:103], v21 offset:8320
    v_exp_f32 v228, v148
    v_exp_f32 v229, v149
    v_mfma_f32_16x16x32_f16 v[192:195], v[240:243], v[184:187], v[192:195]
    v_exp_f32 v230, v150
    v_mfma_f32_32x32x16_bf16 v[132:147], v[48:51], v[112:115], v[132:147]
    s_waitcnt lgkmcnt(4)
    ds_read_b128 v[104:107], v21 offset:8576
    v_cvt_pk_f16_f32 v188, v228, v229
    v_exp_f32 v231, v151
    v_pk_add_f16 v188, v188, v6
    v_mfma_f32_32x32x16_bf16 v[132:147], v[52:55], v[116:119], v[132:147]
    s_waitcnt lgkmcnt(4)
    ds_read_b128 v[108:111], v21 offset:8832
    v_exp_f32 v232, v152
    v_cvt_pk_f16_f32 v189, v230, v231
    v_rcp_f16 v180, v188
    v_mfma_f32_32x32x16_bf16 v[132:147], v[56:59], v[120:123], v[132:147]
    s_waitcnt lgkmcnt(4)
    ds_read_b128 v[112:115], v21 offset:9088
    ds_write_b32 v22, v192 offset:1536
    v_exp_f32 v233, v153
    v_pk_add_f16 v189, v189, v6
    v_rcp_f16_sdwa v180, v188 dst_sel:WORD_1 dst_unused:UNUSED_PRESERVE src0_sel:WORD_1
    v_mfma_f32_32x32x16_bf16 v[132:147], v[60:63], v[124:127], v[132:147]
    s_waitcnt lgkmcnt(5)
    ds_read_b128 v[116:119], v21 offset:8352
    ds_read_b128 v[164:167], v32 offset:0
    v_exp_f32 v234, v154
    v_cvt_pk_f16_f32 v190, v232, v233
    v_rcp_f16 v181, v189
    v_mfma_f32_32x32x16_bf16 v[132:147], v[64:67], v[128:131], v[132:147]
    s_waitcnt lgkmcnt(6)
    ds_read_b128 v[120:123], v21 offset:8608
    ds_read_b128 v[168:171], v32 offset:512
    v_exp_f32 v235, v155
    v_pk_add_f16 v190, v190, v6
    v_rcp_f16_sdwa v181, v189 dst_sel:WORD_1 dst_unused:UNUSED_PRESERVE src0_sel:WORD_1
    v_mfma_f32_32x32x16_bf16 v[132:147], v[68:71], v[100:103], v[132:147]
    s_waitcnt lgkmcnt(7)
    ds_read_b128 v[124:127], v21 offset:8864
    ds_read_b128 v[172:175], v32 offset:1024
    v_exp_f32 v228, v156
    v_cvt_pk_f16_f32 v191, v234, v235
    v_rcp_f16 v182, v190
    v_mfma_f32_32x32x16_bf16 v[132:147], v[72:75], v[104:107], v[132:147]
    s_waitcnt lgkmcnt(8)
    ds_read_b128 v[128:131], v21 offset:9120
    ds_read_b128 v[176:179], v32 offset:1536
    v_exp_f32 v229, v157
    v_pk_add_f16 v191, v191, v6
    v_rcp_f16_sdwa v182, v190 dst_sel:WORD_1 dst_unused:UNUSED_PRESERVE src0_sel:WORD_1
    v_mfma_f32_32x32x16_bf16 v[132:147], v[76:79], v[108:111], v[132:147]
    s_waitcnt lgkmcnt(9)
    ds_read_b128 v[100:103], v17 offset:0
    v_exp_f32 v230, v158
    v_cvt_pk_f16_f32 v188, v228, v229
    v_rcp_f16 v183, v191
    v_mfma_f32_32x32x16_bf16 v[132:147], v[80:83], v[112:115], v[132:147]
    s_waitcnt lgkmcnt(6)
    ds_read_b128 v[104:107], v17 offset:32
    v_exp_f32_e64 v231, v159
    v_pk_add_f16 v188, v188, v6
    v_rcp_f16_sdwa v183, v191 dst_sel:WORD_1 dst_unused:UNUSED_PRESERVE src0_sel:WORD_1
    v_mfma_f32_32x32x16_bf16 v[132:147], v[84:87], v[116:119], v[132:147]
    ds_read_b128 v[108:111], v18 offset:0
    v_exp_f32 v232, v160
    v_cvt_pk_f16_f32 v189, v230, v231
    v_rcp_f16 v184, v188
    v_mfma_f32_16x16x32_f16 v[192:195], v[236:239], v[180:183], 0
    v_exp_f32 v233, v161
    v_mfma_f32_32x32x16_bf16 v[132:147], v[88:91], v[120:123], v[132:147]
    s_waitcnt lgkmcnt(6)
    ds_read_b128 v[112:115], v18 offset:32
    v_pk_add_f16 v189, v189, v6
    v_rcp_f16_sdwa v184, v188 dst_sel:WORD_1 dst_unused:UNUSED_PRESERVE src0_sel:WORD_1
    v_exp_f32 v234, v162
    v_mfma_f32_32x32x16_bf16 v[132:147], v[92:95], v[124:127], v[132:147]
    s_waitcnt lgkmcnt(3)
    ds_read_b128 v[116:119], v19 offset:0
    v_cvt_pk_f16_f32 v190, v232, v233
    v_rcp_f16 v185, v189
    v_exp_f32 v235, v163
    v_mfma_f32_32x32x16_bf16 v[148:163], v[96:99], v[128:131], v[132:147]
    ds_read_b128 v[120:123], v19 offset:32
    v_pk_add_f16 v190, v190, v6
    v_rcp_f16_sdwa v185, v189 dst_sel:WORD_1 dst_unused:UNUSED_PRESERVE src0_sel:WORD_1
    v_cvt_pk_f16_f32 v191, v234, v235
    v_mfma_f32_32x32x16_bf16 v[132:147], v[36:39], v[100:103], v[164:179]
    s_waitcnt lgkmcnt(4)
    ds_read_b128 v[124:127], v20 offset:0
    v_rcp_f16 v186, v190
    v_pk_add_f16 v191, v191, v6
    v_rcp_f16 v187, v191
    v_mfma_f32_32x32x16_bf16 v[132:147], v[40:43], v[104:107], v[132:147]
    s_waitcnt lgkmcnt(3)
    ds_read_b128 v[128:131], v20 offset:32
    v_rcp_f16_sdwa v186, v190 dst_sel:WORD_1 dst_unused:UNUSED_PRESERVE src0_sel:WORD_1
    v_rcp_f16_sdwa v187, v191 dst_sel:WORD_1 dst_unused:UNUSED_PRESERVE src0_sel:WORD_1
    v_mfma_f32_32x32x16_bf16 v[132:147], v[44:47], v[108:111], v[132:147]
    s_barrier
    ds_read_b128 v[100:103], v21 offset:0
    v_exp_f32 v228, v148
    v_exp_f32 v229, v149
    v_mfma_f32_16x16x32_f16 v[192:195], v[240:243], v[184:187], v[192:195]
    v_exp_f32 v230, v150
    v_mfma_f32_32x32x16_bf16 v[132:147], v[48:51], v[112:115], v[132:147]
    s_waitcnt lgkmcnt(4)
    ds_read_b128 v[104:107], v21 offset:256
    v_cvt_pk_f16_f32 v188, v228, v229
    v_exp_f32 v231, v151
    v_pk_add_f16 v188, v188, v6
    v_mfma_f32_32x32x16_bf16 v[132:147], v[52:55], v[116:119], v[132:147]
    s_waitcnt lgkmcnt(4)
    ds_read_b128 v[108:111], v21 offset:512
    v_exp_f32 v232, v152
    v_cvt_pk_f16_f32 v189, v230, v231
    v_rcp_f16 v180, v188
    v_mfma_f32_32x32x16_bf16 v[132:147], v[56:59], v[120:123], v[132:147]
    s_waitcnt lgkmcnt(4)
    ds_read_b128 v[112:115], v21 offset:768
    ds_write_b32 v22, v192 offset:2048
    v_exp_f32 v233, v153
    v_pk_add_f16 v189, v189, v6
    v_rcp_f16_sdwa v180, v188 dst_sel:WORD_1 dst_unused:UNUSED_PRESERVE src0_sel:WORD_1
    v_mfma_f32_32x32x16_bf16 v[132:147], v[60:63], v[124:127], v[132:147]
    s_waitcnt lgkmcnt(5)
    ds_read_b128 v[116:119], v21 offset:32
    ds_read_b128 v[164:167], v33 offset:0
    v_exp_f32 v234, v154
    v_cvt_pk_f16_f32 v190, v232, v233
    v_rcp_f16 v181, v189
    v_mfma_f32_32x32x16_bf16 v[132:147], v[64:67], v[128:131], v[132:147]
    s_waitcnt lgkmcnt(6)
    ds_read_b128 v[120:123], v21 offset:288
    ds_read_b128 v[168:171], v33 offset:512
    v_exp_f32 v235, v155
    v_pk_add_f16 v190, v190, v6
    v_rcp_f16_sdwa v181, v189 dst_sel:WORD_1 dst_unused:UNUSED_PRESERVE src0_sel:WORD_1
    v_mfma_f32_32x32x16_bf16 v[132:147], v[68:71], v[100:103], v[132:147]
    s_waitcnt lgkmcnt(7)
    ds_read_b128 v[124:127], v21 offset:544
    ds_read_b128 v[172:175], v33 offset:1024
    v_exp_f32 v228, v156
    v_cvt_pk_f16_f32 v191, v234, v235
    v_rcp_f16 v182, v190
    v_mfma_f32_32x32x16_bf16 v[132:147], v[72:75], v[104:107], v[132:147]
    s_waitcnt lgkmcnt(8)
    ds_read_b128 v[128:131], v21 offset:800
    ds_read_b128 v[176:179], v33 offset:1536
    v_exp_f32 v229, v157
    v_pk_add_f16 v191, v191, v6
    v_rcp_f16_sdwa v182, v190 dst_sel:WORD_1 dst_unused:UNUSED_PRESERVE src0_sel:WORD_1
    v_mfma_f32_32x32x16_bf16 v[132:147], v[76:79], v[108:111], v[132:147]
    s_waitcnt lgkmcnt(9)
    ds_read_b128 v[100:103], v17 offset:8320
    v_exp_f32 v230, v158
    v_cvt_pk_f16_f32 v188, v228, v229
    v_rcp_f16 v183, v191
    v_mfma_f32_32x32x16_bf16 v[132:147], v[80:83], v[112:115], v[132:147]
    s_waitcnt lgkmcnt(6)
    ds_read_b128 v[104:107], v17 offset:8352
    v_exp_f32 v231, v159
    v_pk_add_f16 v188, v188, v6
    v_rcp_f16_sdwa v183, v191 dst_sel:WORD_1 dst_unused:UNUSED_PRESERVE src0_sel:WORD_1
    v_mfma_f32_32x32x16_bf16 v[132:147], v[84:87], v[116:119], v[132:147]
    s_cmp_eq_u32 s29, 7
    ds_read_b128 v[108:111], v18 offset:8320
    v_exp_f32 v232, v160
    v_cvt_pk_f16_f32 v189, v230, v231
    v_rcp_f16 v184, v188
    v_mfma_f32_16x16x32_f16 v[192:195], v[236:239], v[180:183], 0
    v_exp_f32 v233, v161
    v_mfma_f32_32x32x16_bf16 v[132:147], v[88:91], v[120:123], v[132:147]
    s_waitcnt lgkmcnt(6)
    ds_read_b128 v[112:115], v18 offset:8352
    v_pk_add_f16 v189, v189, v6
    v_rcp_f16_sdwa v184, v188 dst_sel:WORD_1 dst_unused:UNUSED_PRESERVE src0_sel:WORD_1
    v_exp_f32 v234, v162
    v_mfma_f32_32x32x16_bf16 v[132:147], v[92:95], v[124:127], v[132:147]
    s_waitcnt lgkmcnt(3)
    ds_read_b128 v[116:119], v19 offset:8320
    v_cvt_pk_f16_f32 v190, v232, v233
    v_rcp_f16 v185, v189
    v_exp_f32 v235, v163
    v_mfma_f32_32x32x16_bf16 v[148:163], v[96:99], v[128:131], v[132:147]
    s_cbranch_scc1 L_drain
    ds_read_b128 v[120:123], v19 offset:8352
    v_pk_add_f16 v190, v190, v6
    v_rcp_f16_sdwa v185, v189 dst_sel:WORD_1 dst_unused:UNUSED_PRESERVE src0_sel:WORD_1
    v_cvt_pk_f16_f32 v191, v234, v235
    v_mfma_f32_32x32x16_bf16 v[132:147], v[36:39], v[100:103], v[164:179]
    s_waitcnt lgkmcnt(4)
    ds_read_b128 v[124:127], v20 offset:8320
    v_rcp_f16 v186, v190
    v_pk_add_f16 v191, v191, v6
    v_rcp_f16 v187, v191
    v_mfma_f32_32x32x16_bf16 v[132:147], v[40:43], v[104:107], v[132:147]
    s_waitcnt lgkmcnt(3)
    ds_read_b128 v[128:131], v20 offset:8352
    v_rcp_f16_sdwa v186, v190 dst_sel:WORD_1 dst_unused:UNUSED_PRESERVE src0_sel:WORD_1
    v_rcp_f16_sdwa v187, v191 dst_sel:WORD_1 dst_unused:UNUSED_PRESERVE src0_sel:WORD_1
    v_mfma_f32_32x32x16_bf16 v[132:147], v[44:47], v[108:111], v[132:147]
    s_barrier
    ds_read_b128 v[100:103], v21 offset:8320
    v_exp_f32 v228, v148
    v_exp_f32 v229, v149
    v_mfma_f32_16x16x32_f16 v[192:195], v[240:243], v[184:187], v[192:195]
    v_exp_f32 v230, v150
    v_mfma_f32_32x32x16_bf16 v[132:147], v[48:51], v[112:115], v[132:147]
    s_waitcnt lgkmcnt(4)
    ds_read_b128 v[104:107], v21 offset:8576
    v_cvt_pk_f16_f32 v188, v228, v229
    v_exp_f32 v231, v151
    v_pk_add_f16 v188, v188, v6
    v_mfma_f32_32x32x16_bf16 v[132:147], v[52:55], v[116:119], v[132:147]
    s_waitcnt lgkmcnt(4)
    ds_read_b128 v[108:111], v21 offset:8832
    v_exp_f32 v232, v152
    v_cvt_pk_f16_f32 v189, v230, v231
    v_rcp_f16 v180, v188
    v_mfma_f32_32x32x16_bf16 v[132:147], v[56:59], v[120:123], v[132:147]
    s_waitcnt lgkmcnt(4)
    ds_read_b128 v[112:115], v21 offset:9088
    ds_write_b32 v22, v192 offset:2560
    v_exp_f32 v233, v153
    v_pk_add_f16 v189, v189, v6
    v_rcp_f16_sdwa v180, v188 dst_sel:WORD_1 dst_unused:UNUSED_PRESERVE src0_sel:WORD_1
    v_mfma_f32_32x32x16_bf16 v[132:147], v[60:63], v[124:127], v[132:147]
    s_waitcnt lgkmcnt(5)
    ds_read_b128 v[116:119], v21 offset:8352
    ds_read_b128 v[164:167], v34 offset:0
    v_exp_f32 v234, v154
    v_cvt_pk_f16_f32 v190, v232, v233
    v_rcp_f16 v181, v189
    v_mfma_f32_32x32x16_bf16 v[132:147], v[64:67], v[128:131], v[132:147]
    s_waitcnt lgkmcnt(6)
    ds_read_b128 v[120:123], v21 offset:8608
    ds_read_b128 v[168:171], v34 offset:512
    v_exp_f32 v235, v155
    v_pk_add_f16 v190, v190, v6
    v_rcp_f16_sdwa v181, v189 dst_sel:WORD_1 dst_unused:UNUSED_PRESERVE src0_sel:WORD_1
    v_mfma_f32_32x32x16_bf16 v[132:147], v[68:71], v[100:103], v[132:147]
    s_waitcnt lgkmcnt(7)
    ds_read_b128 v[124:127], v21 offset:8864
    ds_read_b128 v[172:175], v34 offset:1024
    v_exp_f32 v228, v156
    v_cvt_pk_f16_f32 v191, v234, v235
    v_rcp_f16 v182, v190
    v_mfma_f32_32x32x16_bf16 v[132:147], v[72:75], v[104:107], v[132:147]
    s_waitcnt lgkmcnt(8)
    ds_read_b128 v[128:131], v21 offset:9120
    ds_read_b128 v[176:179], v34 offset:1536
    v_exp_f32 v229, v157
    v_pk_add_f16 v191, v191, v6
    v_rcp_f16_sdwa v182, v190 dst_sel:WORD_1 dst_unused:UNUSED_PRESERVE src0_sel:WORD_1
    v_mfma_f32_32x32x16_bf16 v[132:147], v[76:79], v[108:111], v[132:147]
    s_waitcnt lgkmcnt(9)
    ds_read_b128 v[100:103], v17 offset:16640
    v_exp_f32 v230, v158
    v_cvt_pk_f16_f32 v188, v228, v229
    v_rcp_f16 v183, v191
    v_mfma_f32_32x32x16_bf16 v[132:147], v[80:83], v[112:115], v[132:147]
    s_waitcnt lgkmcnt(6)
    ds_read_b128 v[104:107], v17 offset:16672
    v_exp_f32 v231, v159
    v_pk_add_f16 v188, v188, v6
    v_rcp_f16_sdwa v183, v191 dst_sel:WORD_1 dst_unused:UNUSED_PRESERVE src0_sel:WORD_1
    v_mfma_f32_32x32x16_bf16 v[132:147], v[84:87], v[116:119], v[132:147]
    s_cmp_eq_u32 s29, 8
    ds_read_b128 v[108:111], v18 offset:16640
    v_exp_f32 v232, v160
    v_cvt_pk_f16_f32 v189, v230, v231
    v_rcp_f16 v184, v188
    v_mfma_f32_16x16x32_f16 v[192:195], v[236:239], v[180:183], 0
    v_exp_f32 v233, v161
    v_mfma_f32_32x32x16_bf16 v[132:147], v[88:91], v[120:123], v[132:147]
    s_waitcnt lgkmcnt(6)
    ds_read_b128 v[112:115], v18 offset:16672
    v_pk_add_f16 v189, v189, v6
    v_rcp_f16_sdwa v184, v188 dst_sel:WORD_1 dst_unused:UNUSED_PRESERVE src0_sel:WORD_1
    v_exp_f32 v234, v162
    v_mfma_f32_32x32x16_bf16 v[132:147], v[92:95], v[124:127], v[132:147]
    s_waitcnt lgkmcnt(3)
    ds_read_b128 v[116:119], v19 offset:16640
    v_cvt_pk_f16_f32 v190, v232, v233
    v_rcp_f16 v185, v189
    v_exp_f32 v235, v163
    v_mfma_f32_32x32x16_bf16 v[148:163], v[96:99], v[128:131], v[132:147]
    s_cbranch_scc1 L_drain
    ds_read_b128 v[120:123], v19 offset:16672
    v_pk_add_f16 v190, v190, v6
    v_rcp_f16_sdwa v185, v189 dst_sel:WORD_1 dst_unused:UNUSED_PRESERVE src0_sel:WORD_1
    v_cvt_pk_f16_f32 v191, v234, v235
    v_mfma_f32_32x32x16_bf16 v[132:147], v[36:39], v[100:103], v[164:179]
    s_waitcnt lgkmcnt(4)
    ds_read_b128 v[124:127], v20 offset:16640
    v_rcp_f16 v186, v190
    v_pk_add_f16 v191, v191, v6
    v_rcp_f16 v187, v191
    v_mfma_f32_32x32x16_bf16 v[132:147], v[40:43], v[104:107], v[132:147]
    s_waitcnt lgkmcnt(3)
    ds_read_b128 v[128:131], v20 offset:16672
    v_rcp_f16_sdwa v186, v190 dst_sel:WORD_1 dst_unused:UNUSED_PRESERVE src0_sel:WORD_1
    v_rcp_f16_sdwa v187, v191 dst_sel:WORD_1 dst_unused:UNUSED_PRESERVE src0_sel:WORD_1
    v_mfma_f32_32x32x16_bf16 v[132:147], v[44:47], v[108:111], v[132:147]
    s_barrier
    ds_read_b128 v[100:103], v21 offset:0
    v_exp_f32 v228, v148
    v_exp_f32 v229, v149
    v_mfma_f32_16x16x32_f16 v[192:195], v[240:243], v[184:187], v[192:195]
    v_exp_f32 v230, v150
    v_mfma_f32_32x32x16_bf16 v[132:147], v[48:51], v[112:115], v[132:147]
    s_waitcnt lgkmcnt(4)
    ds_read_b128 v[104:107], v21 offset:256
    v_cvt_pk_f16_f32 v188, v228, v229
    v_exp_f32 v231, v151
    v_pk_add_f16 v188, v188, v6
    v_mfma_f32_32x32x16_bf16 v[132:147], v[52:55], v[116:119], v[132:147]
    s_waitcnt lgkmcnt(4)
    ds_read_b128 v[108:111], v21 offset:512
    v_exp_f32 v232, v152
    v_cvt_pk_f16_f32 v189, v230, v231
    v_rcp_f16 v180, v188
    v_mfma_f32_32x32x16_bf16 v[132:147], v[56:59], v[120:123], v[132:147]
    s_waitcnt lgkmcnt(4)
    ds_read_b128 v[112:115], v21 offset:768
    ds_write_b32 v22, v192 offset:3072
    v_exp_f32 v233, v153
    v_pk_add_f16 v189, v189, v6
    v_rcp_f16_sdwa v180, v188 dst_sel:WORD_1 dst_unused:UNUSED_PRESERVE src0_sel:WORD_1
    v_mfma_f32_32x32x16_bf16 v[132:147], v[60:63], v[124:127], v[132:147]
    s_waitcnt lgkmcnt(5)
    ds_read_b128 v[116:119], v21 offset:32
    ds_read_b128 v[164:167], v35 offset:0
    v_exp_f32 v234, v154
    v_cvt_pk_f16_f32 v190, v232, v233
    v_rcp_f16 v181, v189
    v_mfma_f32_32x32x16_bf16 v[132:147], v[64:67], v[128:131], v[132:147]
    s_waitcnt lgkmcnt(6)
    ds_read_b128 v[120:123], v21 offset:288
    ds_read_b128 v[168:171], v35 offset:512
    v_exp_f32 v235, v155
    v_pk_add_f16 v190, v190, v6
    v_rcp_f16_sdwa v181, v189 dst_sel:WORD_1 dst_unused:UNUSED_PRESERVE src0_sel:WORD_1
    v_mfma_f32_32x32x16_bf16 v[132:147], v[68:71], v[100:103], v[132:147]
    s_waitcnt lgkmcnt(7)
    ds_read_b128 v[124:127], v21 offset:544
    ds_read_b128 v[172:175], v35 offset:1024
    v_exp_f32 v228, v156
    v_cvt_pk_f16_f32 v191, v234, v235
    v_rcp_f16 v182, v190
    v_mfma_f32_32x32x16_bf16 v[132:147], v[72:75], v[104:107], v[132:147]
    s_waitcnt lgkmcnt(8)
    ds_read_b128 v[128:131], v21 offset:800
    ds_read_b128 v[176:179], v35 offset:1536
    v_exp_f32 v229, v157
    v_pk_add_f16 v191, v191, v6
    v_rcp_f16_sdwa v182, v190 dst_sel:WORD_1 dst_unused:UNUSED_PRESERVE src0_sel:WORD_1
    v_mfma_f32_32x32x16_bf16 v[132:147], v[76:79], v[108:111], v[132:147]
    s_waitcnt lgkmcnt(9)
    ds_read_b128 v[100:103], v17 offset:24960
    v_exp_f32 v230, v158
    v_cvt_pk_f16_f32 v188, v228, v229
    v_rcp_f16 v183, v191
    v_mfma_f32_32x32x16_bf16 v[132:147], v[80:83], v[112:115], v[132:147]
    s_waitcnt lgkmcnt(6)
    ds_read_b128 v[104:107], v17 offset:24992
    v_exp_f32 v231, v159
    v_pk_add_f16 v188, v188, v6
    v_rcp_f16_sdwa v183, v191 dst_sel:WORD_1 dst_unused:UNUSED_PRESERVE src0_sel:WORD_1
    v_mfma_f32_32x32x16_bf16 v[132:147], v[84:87], v[116:119], v[132:147]
    s_cmp_eq_u32 s29, 9
    ds_read_b128 v[108:111], v18 offset:24960
    v_exp_f32 v232, v160
    v_cvt_pk_f16_f32 v189, v230, v231
    v_rcp_f16 v184, v188
    v_mfma_f32_16x16x32_f16 v[192:195], v[236:239], v[180:183], 0
    v_exp_f32 v233, v161
    v_mfma_f32_32x32x16_bf16 v[132:147], v[88:91], v[120:123], v[132:147]
    s_waitcnt lgkmcnt(6)
    ds_read_b128 v[112:115], v18 offset:24992
    v_pk_add_f16 v189, v189, v6
    v_rcp_f16_sdwa v184, v188 dst_sel:WORD_1 dst_unused:UNUSED_PRESERVE src0_sel:WORD_1
    v_exp_f32 v234, v162
    v_mfma_f32_32x32x16_bf16 v[132:147], v[92:95], v[124:127], v[132:147]
    s_waitcnt lgkmcnt(3)
    ds_read_b128 v[116:119], v19 offset:24960
    v_cvt_pk_f16_f32 v190, v232, v233
    v_rcp_f16 v185, v189
    v_exp_f32 v235, v163
    v_mfma_f32_32x32x16_bf16 v[148:163], v[96:99], v[128:131], v[132:147]
    s_cbranch_scc1 L_drain
    ds_read_b128 v[120:123], v19 offset:24992
    v_pk_add_f16 v190, v190, v6
    v_rcp_f16_sdwa v185, v189 dst_sel:WORD_1 dst_unused:UNUSED_PRESERVE src0_sel:WORD_1
    v_cvt_pk_f16_f32 v191, v234, v235
    v_mfma_f32_32x32x16_bf16 v[132:147], v[36:39], v[100:103], v[164:179]
    s_waitcnt lgkmcnt(4)
    ds_read_b128 v[124:127], v20 offset:24960
    v_rcp_f16 v186, v190
    v_pk_add_f16 v191, v191, v6
    v_rcp_f16 v187, v191
    v_mfma_f32_32x32x16_bf16 v[132:147], v[40:43], v[104:107], v[132:147]
    s_waitcnt lgkmcnt(3)
    ds_read_b128 v[128:131], v20 offset:24992
    v_rcp_f16_sdwa v186, v190 dst_sel:WORD_1 dst_unused:UNUSED_PRESERVE src0_sel:WORD_1
    v_rcp_f16_sdwa v187, v191 dst_sel:WORD_1 dst_unused:UNUSED_PRESERVE src0_sel:WORD_1
    v_mfma_f32_32x32x16_bf16 v[132:147], v[44:47], v[108:111], v[132:147]
    s_barrier
    ds_read_b128 v[100:103], v21 offset:8320
    v_exp_f32 v228, v148
    v_exp_f32 v229, v149
    v_mfma_f32_16x16x32_f16 v[192:195], v[240:243], v[184:187], v[192:195]
    v_exp_f32 v230, v150
    v_mfma_f32_32x32x16_bf16 v[132:147], v[48:51], v[112:115], v[132:147]
    s_waitcnt lgkmcnt(4)
    ds_read_b128 v[104:107], v21 offset:8576
    v_cvt_pk_f16_f32 v188, v228, v229
    v_exp_f32 v231, v151
    v_pk_add_f16 v188, v188, v6
    v_mfma_f32_32x32x16_bf16 v[132:147], v[52:55], v[116:119], v[132:147]
    s_waitcnt lgkmcnt(4)
    ds_read_b128 v[108:111], v21 offset:8832
    v_exp_f32 v232, v152
    v_cvt_pk_f16_f32 v189, v230, v231
    v_rcp_f16 v180, v188
    v_mfma_f32_32x32x16_bf16 v[132:147], v[56:59], v[120:123], v[132:147]
    s_waitcnt lgkmcnt(4)
    ds_read_b128 v[112:115], v21 offset:9088
    ds_write_b32 v22, v192 offset:3584
    v_exp_f32 v233, v153
    v_pk_add_f16 v189, v189, v6
    v_rcp_f16_sdwa v180, v188 dst_sel:WORD_1 dst_unused:UNUSED_PRESERVE src0_sel:WORD_1
    v_mfma_f32_32x32x16_bf16 v[132:147], v[60:63], v[124:127], v[132:147]
    s_waitcnt lgkmcnt(5)
    ds_read_b128 v[116:119], v21 offset:8352
    v_exp_f32 v234, v154
    v_cvt_pk_f16_f32 v190, v232, v233
    v_rcp_f16 v181, v189
    v_mfma_f32_32x32x16_bf16 v[132:147], v[64:67], v[128:131], v[132:147]
    s_waitcnt lgkmcnt(5)
    ds_read_b128 v[120:123], v21 offset:8608
    v_exp_f32 v235, v155
    v_pk_add_f16 v190, v190, v6
    v_rcp_f16_sdwa v181, v189 dst_sel:WORD_1 dst_unused:UNUSED_PRESERVE src0_sel:WORD_1
    v_mfma_f32_32x32x16_bf16 v[132:147], v[68:71], v[100:103], v[132:147]
    s_waitcnt lgkmcnt(5)
    ds_read_b128 v[124:127], v21 offset:8864
    v_exp_f32 v228, v156
    v_cvt_pk_f16_f32 v191, v234, v235
    v_rcp_f16 v182, v190
    v_mfma_f32_32x32x16_bf16 v[132:147], v[72:75], v[104:107], v[132:147]
    s_waitcnt lgkmcnt(5)
    ds_read_b128 v[128:131], v21 offset:9120
    v_exp_f32 v229, v157
    v_pk_add_f16 v191, v191, v6
    v_rcp_f16_sdwa v182, v190 dst_sel:WORD_1 dst_unused:UNUSED_PRESERVE src0_sel:WORD_1
    v_mfma_f32_32x32x16_bf16 v[132:147], v[76:79], v[108:111], v[132:147]
    s_waitcnt lgkmcnt(5)
    ds_read_b128 v[100:103], v17 offset:33280
    v_exp_f32 v230, v158
    v_cvt_pk_f16_f32 v188, v228, v229
    v_rcp_f16 v183, v191
    v_mfma_f32_32x32x16_bf16 v[132:147], v[80:83], v[112:115], v[132:147]
    s_waitcnt lgkmcnt(3)
    ds_read_b128 v[104:107], v17 offset:33312
    v_exp_f32 v231, v159
    v_pk_add_f16 v188, v188, v6
    v_rcp_f16_sdwa v183, v191 dst_sel:WORD_1 dst_unused:UNUSED_PRESERVE src0_sel:WORD_1
    v_mfma_f32_32x32x16_bf16 v[132:147], v[84:87], v[116:119], v[132:147]
    s_nop 0
    ds_read_b128 v[108:111], v18 offset:33280
    v_exp_f32 v232, v160
    v_cvt_pk_f16_f32 v189, v230, v231
    v_rcp_f16 v184, v188
    v_mfma_f32_16x16x32_f16 v[192:195], v[236:239], v[180:183], 0
    v_exp_f32 v233, v161
    v_mfma_f32_32x32x16_bf16 v[132:147], v[88:91], v[120:123], v[132:147]
    s_waitcnt lgkmcnt(4)
    ds_read_b128 v[112:115], v18 offset:33312
    v_pk_add_f16 v189, v189, v6
    v_rcp_f16_sdwa v184, v188 dst_sel:WORD_1 dst_unused:UNUSED_PRESERVE src0_sel:WORD_1
    v_exp_f32 v234, v162
    v_mfma_f32_32x32x16_bf16 v[132:147], v[92:95], v[124:127], v[132:147]
    s_waitcnt lgkmcnt(3)
    ds_read_b128 v[116:119], v19 offset:33280
    v_cvt_pk_f16_f32 v190, v232, v233
    v_rcp_f16 v185, v189
    v_exp_f32 v235, v163
    v_mfma_f32_32x32x16_bf16 v[148:163], v[96:99], v[128:131], v[132:147]
    s_branch L_drain
L_pmore:
    ds_read_b64_tr_b16 v[92:93], v14 offset:0
    ds_read_b64_tr_b16 v[94:95], v14 offset:1040
    ds_read_b64_tr_b16 v[96:97], v14 offset:32
    s_waitcnt lgkmcnt(8)
    ds_read_b64_tr_b16 v[98:99], v14 offset:1072
    ds_read_b64_tr_b16 v[100:101], v14 offset:8320
    ds_read_b64_tr_b16 v[102:103], v14 offset:9360
    ds_read_b64_tr_b16 v[104:105], v14 offset:8352
    ds_read_b64_tr_b16 v[106:107], v14 offset:9392
    v_add_u32_dpp v84, v33, v11 row_newbcast:12 row_mask:0xf bank_mask:0xf
    v_add_u32_dpp v85, v33, v11 row_newbcast:13 row_mask:0xf bank_mask:0xf
    v_add_u32_dpp v64, v34, v12 row_newbcast:12 row_mask:0xf bank_mask:0xf
    v_add_u32_dpp v65, v34, v12 row_newbcast:13 row_mask:0xf bank_mask:0xf
    v_add_u32_dpp v86, v33, v11 row_newbcast:14 row_mask:0xf bank_mask:0xf
    v_add_u32_dpp v87, v33, v11 row_newbcast:15 row_mask:0xf bank_mask:0xf
    v_add_u32_dpp v66, v34, v12 row_newbcast:14 row_mask:0xf bank_mask:0xf
    v_add_u32_dpp v67, v34, v12 row_newbcast:15 row_mask:0xf bank_mask:0xf
    s_add_u32 m0, s35, 41600
    s_nop 0
    buffer_load_dwordx4 v82, s[36:39], 0 offen nt lds
    s_add_u32 m0, s35, 42640
    s_nop 0
    buffer_load_dwordx4 v83, s[36:39], 0 offen nt lds
    s_waitcnt vmcnt(4)
    ds_read_b128 v[172:175], v13 offset:24960
    ds_read_b128 v[176:179], v13 offset:26000
    s_waitcnt lgkmcnt(2)
    s_barrier
    s_add_u32 m0, s35, 0
    s_nop 0
    buffer_load_dwordx4 v84, s[36:39], 0 offen nt lds
    s_add_u32 m0, s35, 1040
    s_nop 0
    buffer_load_dwordx4 v85, s[36:39], 0 offen nt lds
    s_add_u32 m0, s35, 8320
    s_nop 0
    buffer_load_dwordx4 v86, s[36:39], 0 offen nt lds
    s_add_u32 m0, s35, 9360
    s_nop 0
    buffer_load_dwordx4 v87, s[36:39], 0 offen nt lds
    ds_read_b128 v[180:183], v60
    ds_read_b128 v[184:187], v60 offset:4096
    ds_read_b128 v[188:191], v61
    ds_read_b128 v[192:195], v61 offset:4096
    s_mov_b32 m0, s50
    s_waitcnt lgkmcnt(4)
    v_lshlrev_b32 v156, 16, v172
    v_and_b32 v157, v42, v172
    v_lshlrev_b32 v158, 16, v173
    v_and_b32 v159, v42, v173
    v_lshlrev_b32 v160, 16, v174
    v_and_b32 v161, v42, v174
    s_setprio 2
    v_lshlrev_b32 v162, 16, v175
    v_and_b32 v163, v42, v175
    v_lshlrev_b32 v164, 16, v176
    v_and_b32 v165, v42, v176
    v_lshlrev_b32 v166, 16, v177
    v_and_b32 v167, v42, v177
    v_lshlrev_b32 v168, 16, v178
    v_and_b32 v169, v42, v178
    v_lshlrev_b32 v170, 16, v179
    v_and_b32 v171, v42, v179
    v_pk_mul_f32 v[156:157], v[156:157], v[196:197]
    v_pk_mul_f32 v[158:159], v[158:159], v[198:199]
    v_pk_mul_f32 v[160:161], v[160:161], v[200:201]
    v_pk_mul_f32 v[162:163], v[162:163], v[202:203]
    v_pk_mul_f32 v[164:165], v[164:165], v[204:205]
    v_pk_mul_f32 v[166:167], v[166:167], v[206:207]
    v_pk_mul_f32 v[168:169], v[168:169], v[208:209]
    v_pk_mul_f32 v[170:171], v[170:171], v[210:211]
    s_setprio 0
    v_cvt_pk_bf16_f32 v212, v156, v157
    v_cvt_pk_bf16_f32 v213, v158, v159
    v_cvt_pk_bf16_f32 v214, v160, v161
    v_cvt_pk_bf16_f32 v215, v162, v163
    v_cvt_pk_bf16_f32 v216, v164, v165
    v_cvt_pk_bf16_f32 v217, v166, v167
    v_cvt_pk_bf16_f32 v218, v168, v169
    v_cvt_pk_bf16_f32 v219, v170, v171
    ds_write_addtid_b32 v212 offset:8320
    ds_write_addtid_b32 v213 offset:8576
    ds_write_addtid_b32 v214 offset:8832
    ds_write_addtid_b32 v215 offset:9088
    ds_write_addtid_b32 v216 offset:9360
    ds_write_addtid_b32 v217 offset:9616
    ds_write_addtid_b32 v218 offset:9872
    ds_write_addtid_b32 v219 offset:10128
    s_waitcnt vmcnt(6)
    ds_read_b128 v[172:175], v13 offset:33280
    ds_read_b128 v[176:179], v13 offset:34320
    s_waitcnt lgkmcnt(2)
    s_barrier
    ds_read_b128 v[196:199], v62
    ds_read_b128 v[200:203], v62 offset:4096
    ds_read_b128 v[204:207], v63
    ds_read_b128 v[208:211], v63 offset:4096
    s_mov_b32 m0, s50
    s_waitcnt lgkmcnt(4)
    v_lshlrev_b32 v156, 16, v172
    v_and_b32 v157, v42, v172
    v_lshlrev_b32 v158, 16, v173
    v_and_b32 v159, v42, v173
    v_lshlrev_b32 v160, 16, v174
    v_and_b32 v161, v42, v174
    v_lshlrev_b32 v162, 16, v175
    v_and_b32 v163, v42, v175
    v_lshlrev_b32 v164, 16, v176
    s_setprio 2
    v_and_b32 v165, v42, v176
    v_lshlrev_b32 v166, 16, v177
    v_and_b32 v167, v42, v177
    v_lshlrev_b32 v168, 16, v178
    v_and_b32 v169, v42, v178
    v_lshlrev_b32 v170, 16, v179
    v_and_b32_e64 v171, v42, v179
    v_pk_mul_f32 v[156:157], v[156:157], v[180:181]
    v_pk_mul_f32 v[158:159], v[158:159], v[182:183]
    v_pk_mul_f32 v[160:161], v[160:161], v[184:185]
    v_pk_mul_f32 v[162:163], v[162:163], v[186:187]
    v_pk_mul_f32 v[164:165], v[164:165], v[188:189]
    v_pk_mul_f32 v[166:167], v[166:167], v[190:191]
    v_pk_mul_f32 v[168:169], v[168:169], v[192:193]
    v_pk_mul_f32 v[170:171], v[170:171], v[194:195]
    s_setprio 0
    v_cvt_pk_bf16_f32 v212, v156, v157
    v_cvt_pk_bf16_f32 v213, v158, v159
    v_cvt_pk_bf16_f32 v214, v160, v161
    v_cvt_pk_bf16_f32 v215, v162, v163
    v_cvt_pk_bf16_f32 v216, v164, v165
    v_cvt_pk_bf16_f32 v217, v166, v167
    v_cvt_pk_bf16_f32 v218, v168, v169
    v_cvt_pk_bf16_f32 v219, v170, v171
    ds_write_addtid_b32 v212 offset:0
    ds_write_addtid_b32 v213 offset:256
    ds_write_addtid_b32 v214 offset:512
    ds_write_addtid_b32 v215 offset:768
    ds_write_addtid_b32 v216 offset:1040
    ds_write_addtid_b32 v217 offset:1296
    ds_write_addtid_b32 v218 offset:1552
    ds_write_addtid_b32 v219 offset:1808
    ds_read_b64_tr_b16 v[108:109], v14 offset:16640
    ds_read_b64_tr_b16 v[110:111], v14 offset:17680
    ds_read_b64_tr_b16 v[112:113], v14 offset:16672
    s_waitcnt lgkmcnt(8)
    ds_read_b64_tr_b16 v[114:115], v14 offset:17712
    ds_read_b64_tr_b16 v[116:117], v14 offset:24960
    ds_read_b64_tr_b16 v[118:119], v14 offset:26000
    ds_read_b64_tr_b16 v[120:121], v14 offset:24992
    ds_read_b64_tr_b16 v[122:123], v14 offset:26032
    s_waitcnt vmcnt(4)
    ds_read_b128 v[172:175], v13 offset:41600
    ds_read_b128 v[176:179], v13 offset:42640
    s_waitcnt lgkmcnt(2)
    s_barrier
    s_add_u32 m0, s35, 16640
    s_nop 0
    buffer_load_dwordx4 v88, s[36:39], 0 offen nt lds
    s_add_u32 m0, s35, 17680
    s_nop 0
    buffer_load_dwordx4 v89, s[36:39], 0 offen nt lds
    s_add_u32 m0, s35, 24960
    s_nop 0
    buffer_load_dwordx4 v90, s[36:39], 0 offen nt lds
    s_add_u32 m0, s35, 26000
    s_nop 0
    buffer_load_dwordx4 v91, s[36:39], 0 offen nt lds
    ds_read_b128 v[180:183], v64
    ds_read_b128 v[184:187], v64 offset:4096
    ds_read_b128 v[188:191], v65
    ds_read_b128 v[192:195], v65 offset:4096
    s_mov_b32 m0, s50
    s_waitcnt lgkmcnt(4)
    v_lshlrev_b32 v156, 16, v172
    v_and_b32 v157, v42, v172
    v_lshlrev_b32 v158, 16, v173
    v_and_b32 v159, v42, v173
    v_lshlrev_b32 v160, 16, v174
    v_and_b32 v161, v42, v174
    v_lshlrev_b32 v162, 16, v175
    v_and_b32 v163, v42, v175
    v_lshlrev_b32 v164, 16, v176
    s_setprio 2
    v_and_b32 v165, v42, v176
    v_lshlrev_b32 v166, 16, v177
    v_and_b32 v167, v42, v177
    v_lshlrev_b32 v168, 16, v178
    v_and_b32 v169, v42, v178
    v_lshlrev_b32 v170, 16, v179
    v_and_b32 v171, v42, v179
    v_pk_mul_f32 v[156:157], v[156:157], v[196:197]
    v_pk_mul_f32 v[158:159], v[158:159], v[198:199]
    v_pk_mul_f32 v[160:161], v[160:161], v[200:201]
    v_pk_mul_f32 v[162:163], v[162:163], v[202:203]
    v_pk_mul_f32 v[164:165], v[164:165], v[204:205]
    v_pk_mul_f32 v[166:167], v[166:167], v[206:207]
    v_pk_mul_f32 v[168:169], v[168:169], v[208:209]
    v_pk_mul_f32 v[170:171], v[170:171], v[210:211]
    s_setprio 0
    v_cvt_pk_bf16_f32 v212, v156, v157
    v_cvt_pk_bf16_f32 v213, v158, v159
    v_cvt_pk_bf16_f32 v214, v160, v161
    v_cvt_pk_bf16_f32 v215, v162, v163
    v_cvt_pk_bf16_f32 v216, v164, v165
    v_cvt_pk_bf16_f32 v217, v166, v167
    v_cvt_pk_bf16_f32 v218, v168, v169
    v_cvt_pk_bf16_f32 v219, v170, v171
    ds_write_addtid_b32 v212 offset:8320
    ds_write_addtid_b32 v213 offset:8576
    ds_write_addtid_b32 v214 offset:8832
    ds_write_addtid_b32 v215 offset:9088
    ds_write_addtid_b32 v216 offset:9360
    ds_write_addtid_b32 v217 offset:9616
    ds_write_addtid_b32 v218 offset:9872
    ds_write_addtid_b32 v219 offset:10128
    s_waitcnt vmcnt(6)
    ds_read_b128 v[172:175], v13 offset:0
    ds_read_b128 v[176:179], v13 offset:1040
    s_waitcnt lgkmcnt(2)
    s_barrier
    ds_read_b128 v[196:199], v66
    ds_read_b128 v[200:203], v66 offset:4096
    ds_read_b128 v[204:207], v67
    ds_read_b128 v[208:211], v67 offset:4096
    s_mov_b32 m0, s50
    s_waitcnt lgkmcnt(4)
    v_lshlrev_b32 v156, 16, v172
    v_and_b32 v157, v42, v172
    v_lshlrev_b32 v158, 16, v173
    v_and_b32 v159, v42, v173
    s_setprio 2
    v_lshlrev_b32 v160, 16, v174
    v_and_b32 v161, v42, v174
    v_lshlrev_b32 v162, 16, v175
    v_and_b32 v163, v42, v175
    v_lshlrev_b32 v164, 16, v176
    v_and_b32 v165, v42, v176
    v_lshlrev_b32 v166, 16, v177
    v_and_b32 v167, v42, v177
    v_lshlrev_b32 v168, 16, v178
    v_and_b32 v169, v42, v178
    v_lshlrev_b32 v170, 16, v179
    v_and_b32_e64 v171, v42, v179
    v_pk_mul_f32 v[156:157], v[156:157], v[180:181]
    v_pk_mul_f32 v[158:159], v[158:159], v[182:183]
    v_pk_mul_f32 v[160:161], v[160:161], v[184:185]
    v_pk_mul_f32 v[162:163], v[162:163], v[186:187]
    v_pk_mul_f32 v[164:165], v[164:165], v[188:189]
    v_pk_mul_f32 v[166:167], v[166:167], v[190:191]
    v_pk_mul_f32 v[168:169], v[168:169], v[192:193]
    v_pk_mul_f32 v[170:171], v[170:171], v[194:195]
    s_setprio 0
    v_cvt_pk_bf16_f32 v212, v156, v157
    v_cvt_pk_bf16_f32 v213, v158, v159
    v_cvt_pk_bf16_f32 v214, v160, v161
    v_cvt_pk_bf16_f32 v215, v162, v163
    v_cvt_pk_bf16_f32 v216, v164, v165
    v_cvt_pk_bf16_f32 v217, v166, v167
    v_cvt_pk_bf16_f32 v218, v168, v169
    v_cvt_pk_bf16_f32 v219, v170, v171
    ds_write_addtid_b32 v212 offset:0
    ds_write_addtid_b32 v213 offset:256
    ds_write_addtid_b32 v214 offset:512
    ds_write_addtid_b32 v215 offset:768
    ds_write_addtid_b32 v216 offset:1040
    ds_write_addtid_b32 v217 offset:1296
    ds_write_addtid_b32 v218 offset:1552
    ds_write_addtid_b32 v219 offset:1808
    s_cmp_eq_u32 s30, 7
    s_cbranch_scc1 L_pdone
    s_waitcnt vmcnt(4)
    ds_read_b128 v[172:175], v13 offset:8320
    ds_read_b128 v[176:179], v13 offset:9360
    s_waitcnt lgkmcnt(2)
    s_barrier
    ds_read_b128 v[180:183], v68
    ds_read_b128 v[184:187], v68 offset:4096
    ds_read_b128 v[188:191], v69
    ds_read_b128 v[192:195], v69 offset:4096
    s_mov_b32 m0, s50
    s_waitcnt lgkmcnt(4)
    v_lshlrev_b32 v156, 16, v172
    v_and_b32 v157, v42, v172
    v_lshlrev_b32 v158, 16, v173
    v_and_b32 v159, v42, v173
    s_setprio 2
    v_lshlrev_b32 v160, 16, v174
    v_and_b32 v161, v42, v174
    v_lshlrev_b32 v162, 16, v175
    v_and_b32 v163, v42, v175
    v_lshlrev_b32 v164, 16, v176
    v_and_b32 v165, v42, v176
    v_lshlrev_b32 v166, 16, v177
    v_and_b32 v167, v42, v177
    v_lshlrev_b32 v168, 16, v178
    v_and_b32 v169, v42, v178
    v_lshlrev_b32 v170, 16, v179
    v_and_b32_e64 v171, v42, v179
    v_pk_mul_f32 v[156:157], v[156:157], v[196:197]
    v_pk_mul_f32 v[158:159], v[158:159], v[198:199]
    v_pk_mul_f32 v[160:161], v[160:161], v[200:201]
    v_pk_mul_f32 v[162:163], v[162:163], v[202:203]
    v_pk_mul_f32 v[164:165], v[164:165], v[204:205]
    v_pk_mul_f32 v[166:167], v[166:167], v[206:207]
    v_pk_mul_f32 v[168:169], v[168:169], v[208:209]
    v_pk_mul_f32 v[170:171], v[170:171], v[210:211]
    s_setprio 0
    v_cvt_pk_bf16_f32 v212, v156, v157
    v_cvt_pk_bf16_f32 v213, v158, v159
    v_cvt_pk_bf16_f32 v214, v160, v161
    v_cvt_pk_bf16_f32 v215, v162, v163
    v_cvt_pk_bf16_f32 v216, v164, v165
    v_cvt_pk_bf16_f32 v217, v166, v167
    v_cvt_pk_bf16_f32 v218, v168, v169
    v_cvt_pk_bf16_f32 v219, v170, v171
    ds_write_addtid_b32 v212 offset:8320
    ds_write_addtid_b32 v213 offset:8576
    ds_write_addtid_b32 v214 offset:8832
    ds_write_addtid_b32 v215 offset:9088
    ds_write_addtid_b32 v216 offset:9360
    ds_write_addtid_b32 v217 offset:9616
    ds_write_addtid_b32 v218 offset:9872
    ds_write_addtid_b32 v219 offset:10128
    s_cmp_eq_u32 s30, 8
    s_cbranch_scc1 L_pdone
    s_waitcnt vmcnt(2)
    ds_read_b128 v[172:175], v13 offset:16640
    ds_read_b128 v[176:179], v13 offset:17680
    s_waitcnt lgkmcnt(2)
    s_barrier
    ds_read_b128 v[196:199], v70
    ds_read_b128 v[200:203], v70 offset:4096
    ds_read_b128 v[204:207], v71
    ds_read_b128 v[208:211], v71 offset:4096
    s_mov_b32 m0, s50
    s_waitcnt lgkmcnt(4)
    v_lshlrev_b32 v156, 16, v172
    v_and_b32 v157, v42, v172
    v_lshlrev_b32 v158, 16, v173
    v_and_b32 v159, v42, v173
    s_setprio 2
    v_lshlrev_b32 v160, 16, v174
    v_and_b32 v161, v42, v174
    v_lshlrev_b32 v162, 16, v175
    v_and_b32 v163, v42, v175
    v_lshlrev_b32 v164, 16, v176
    v_and_b32 v165, v42, v176
    v_lshlrev_b32 v166, 16, v177
    v_and_b32 v167, v42, v177
    v_lshlrev_b32 v168, 16, v178
    v_and_b32 v169, v42, v178
    v_lshlrev_b32 v170, 16, v179
    v_and_b32_e64 v171, v42, v179
    v_pk_mul_f32 v[156:157], v[156:157], v[180:181]
    v_pk_mul_f32 v[158:159], v[158:159], v[182:183]
    v_pk_mul_f32 v[160:161], v[160:161], v[184:185]
    v_pk_mul_f32 v[162:163], v[162:163], v[186:187]
    v_pk_mul_f32 v[164:165], v[164:165], v[188:189]
    v_pk_mul_f32 v[166:167], v[166:167], v[190:191]
    v_pk_mul_f32 v[168:169], v[168:169], v[192:193]
    v_pk_mul_f32 v[170:171], v[170:171], v[194:195]
    s_setprio 0
    v_cvt_pk_bf16_f32 v212, v156, v157
    v_cvt_pk_bf16_f32 v213, v158, v159
    v_cvt_pk_bf16_f32 v214, v160, v161
    v_cvt_pk_bf16_f32 v215, v162, v163
    v_cvt_pk_bf16_f32 v216, v164, v165
    v_cvt_pk_bf16_f32 v217, v166, v167
    v_cvt_pk_bf16_f32 v218, v168, v169
    v_cvt_pk_bf16_f32 v219, v170, v171
    ds_write_addtid_b32 v212 offset:0
    ds_write_addtid_b32 v213 offset:256
    ds_write_addtid_b32 v214 offset:512
    ds_write_addtid_b32 v215 offset:768
    ds_write_addtid_b32 v216 offset:1040
    ds_write_addtid_b32 v217 offset:1296
    ds_write_addtid_b32 v218 offset:1552
    ds_write_addtid_b32 v219 offset:1808
    s_cmp_eq_u32 s30, 9
    s_cbranch_scc1 L_pdone
    s_waitcnt vmcnt(0)
    ds_read_b128 v[172:175], v13 offset:24960
    ds_read_b128 v[176:179], v13 offset:26000
    s_waitcnt lgkmcnt(2)
    s_barrier
    s_mov_b32 m0, s50
    s_waitcnt lgkmcnt(0)
    v_lshlrev_b32 v156, 16, v172
    v_and_b32 v157, v42, v172
    v_lshlrev_b32 v158, 16, v173
    v_and_b32 v159, v42, v173
    s_setprio 2
    v_lshlrev_b32 v160, 16, v174
    v_and_b32 v161, v42, v174
    v_lshlrev_b32 v162, 16, v175
    v_and_b32 v163, v42, v175
    v_lshlrev_b32 v164, 16, v176
    v_and_b32 v165, v42, v176
    v_lshlrev_b32 v166, 16, v177
    v_and_b32 v167, v42, v177
    v_lshlrev_b32 v168, 16, v178
    v_and_b32 v169, v42, v178
    v_lshlrev_b32 v170, 16, v179
    v_and_b32_e64 v171, v42, v179
    v_pk_mul_f32 v[156:157], v[156:157], v[196:197]
    v_pk_mul_f32 v[158:159], v[158:159], v[198:199]
    v_pk_mul_f32 v[160:161], v[160:161], v[200:201]
    v_pk_mul_f32 v[162:163], v[162:163], v[202:203]
    v_pk_mul_f32 v[164:165], v[164:165], v[204:205]
    v_pk_mul_f32 v[166:167], v[166:167], v[206:207]
    v_pk_mul_f32 v[168:169], v[168:169], v[208:209]
    v_pk_mul_f32 v[170:171], v[170:171], v[210:211]
    s_setprio 0
    v_cvt_pk_bf16_f32 v212, v156, v157
    v_cvt_pk_bf16_f32 v213, v158, v159
    v_cvt_pk_bf16_f32 v214, v160, v161
    v_cvt_pk_bf16_f32 v215, v162, v163
    v_cvt_pk_bf16_f32 v216, v164, v165
    v_cvt_pk_bf16_f32 v217, v166, v167
    v_cvt_pk_bf16_f32 v218, v168, v169
    v_cvt_pk_bf16_f32 v219, v170, v171
    ds_write_addtid_b32 v212 offset:8320
    ds_write_addtid_b32 v213 offset:8576
    ds_write_addtid_b32 v214 offset:8832
    ds_write_addtid_b32 v215 offset:9088
    ds_write_addtid_b32 v216 offset:9360
    ds_write_addtid_b32 v217 offset:9616
    ds_write_addtid_b32 v218 offset:9872
    ds_write_addtid_b32 v219 offset:10128
    s_branch L_pdone
L_psel2:
    v_add_u32 v30, 256, v30
    v_mov_b32 v3, v35
    v_mov_b32 v4, v33
    v_mov_b32 v5, v34
    v_mov_b64 v[50:51], s[40:41]
    v_mov_b32 v31, v30
    v_mov_b32 v32, 0
    v_cmpx_le_u32 vcc, s10, v30
    v_mov_b64 v[50:51], s[42:43]
    v_subrev_u32 v31, s10, v30
    v_mov_b32 v32, 1
    v_cmpx_le_u32 vcc, s11, v30
    v_mov_b64 v[50:51], s[44:45]
    v_subrev_u32 v31, s11, v30
    v_mov_b32 v32, 2
    v_cmpx_le_u32 vcc, s28, v30
    v_mov_b64 v[50:51], s[46:47]
    v_subrev_u32 v31, s28, v30
    v_mov_b32 v32, 3
    v_cmpx_le_u32 vcc, s29, v30
    v_mov_b64 v[50:51], s[48:49]
    v_subrev_u32 v31, s29, v30
    v_mov_b32 v32, 4
    s_mov_b64 exec, -1
    v_bcnt_u32_b32 v6, v50, 0
    v_sub_co_u32 v6, vcc, v31, v6
    v_min_u32 v31, v31, v6
    s_nop 0
    v_cndmask_b32 v50, v51, v50, vcc
    v_addc_co_u32 v32, vcc, v32, v32, vcc
    v_and_b32 v6, 0xffff, v50
    v_bcnt_u32_b32 v6, v6, 0
    v_sub_co_u32 v6, vcc, v31, v6
    v_min_u32 v31, v31, v6
    v_lshrrev_b32 v7, 16, v50
    v_cndmask_b32 v50, v7, v50, vcc
    v_addc_co_u32 v32, vcc, v32, v32, vcc
    v_and_b32 v6, 0xff, v50
    v_bcnt_u32_b32 v6, v6, 0
    v_sub_co_u32 v6, vcc, v31, v6
    v_min_u32 v31, v31, v6
    v_lshrrev_b32 v7, 8, v50
    v_cndmask_b32 v50, v7, v50, vcc
    v_addc_co_u32 v32, vcc, v32, v32, vcc
    v_and_b32 v6, 0xf, v50
    v_bcnt_u32_b32 v6, v6, 0
    v_sub_co_u32 v6, vcc, v31, v6
    v_min_u32 v31, v31, v6
    v_lshrrev_b32 v7, 4, v50
    v_cndmask_b32 v50, v7, v50, vcc
    v_addc_co_u32 v32, vcc, v32, v32, vcc
    v_and_b32 v6, 0x3, v50
    v_bcnt_u32_b32 v6, v6, 0
    v_sub_co_u32 v6, vcc, v31, v6
    v_min_u32 v31, v31, v6
    v_lshrrev_b32 v7, 2, v50
    v_cndmask_b32 v50, v7, v50, vcc
    v_addc_co_u32 v32, vcc, v32, v32, vcc
    v_and_b32 v6, 1, v50
    v_cmp_lt_u32 vcc, v31, v6
    v_cmp_gt_u32 s[26:27], s31, v30
    v_mov_b32 v7, 0x1ff
    v_addc_co_u32 v32, vcc, v32, v32, vcc
    v_xor_b32 v32, 63, v32
    v_cndmask_b32 v32, v7, v32, s[26:27]
    v_lshlrev_b32 v33, 8, v32
    v_lshl_add_u32 v6, v32, 1, v38
    ds_read_u16 v35, v6
    s_waitcnt lgkmcnt(0)
    v_mul_u32_u24 v34, 3277, v32
    v_bfe_u32 v34, v34, 16, 4
    v_cndmask_b32 v35, 0, v35, s[26:27]
    v_lshlrev_b32 v35, 16, v35
    v_lshl_or_b32 v35, v34, 4, v35
    v_lshlrev_b32 v34, 8, v34
    v_add_u32_dpp v88, v33, v11 row_newbcast:0 row_mask:0xf bank_mask:0xf
    v_add_u32_dpp v89, v33, v11 row_newbcast:1 row_mask:0xf bank_mask:0xf
    v_add_u32_dpp v68, v34, v12 row_newbcast:0 row_mask:0xf bank_mask:0xf
    v_add_u32_dpp v69, v34, v12 row_newbcast:1 row_mask:0xf bank_mask:0xf
    v_add_u32_dpp v90, v33, v11 row_newbcast:2 row_mask:0xf bank_mask:0xf
    v_add_u32_dpp v91, v33, v11 row_newbcast:3 row_mask:0xf bank_mask:0xf
    v_add_u32_dpp v70, v34, v12 row_newbcast:2 row_mask:0xf bank_mask:0xf
    v_add_u32_dpp v71, v34, v12 row_newbcast:3 row_mask:0xf bank_mask:0xf
    s_mov_b32 exec_lo, 0x000f000f
    s_mov_b32 exec_hi, 0x000f000f
    ds_write_b32 v39, v35 offset:1024
    ds_write_b8 v41, v35 offset:8
    s_mov_b64 exec, -1
    s_waitcnt lgkmcnt(0)
    v_mov_b32 v35, v3
    v_mov_b32 v33, v4
    v_mov_b32_e64 v34, v5
    s_mov_b64 vcc, 0
    s_branch L_psel_back
L_ptr2:
    ds_read_b64_tr_b16 v[124:125], v14 offset:33280
    ds_read_b64_tr_b16 v[126:127], v14 offset:34320
    ds_read_b64_tr_b16 v[128:129], v14 offset:33312
    ds_read_b64_tr_b16 v[130:131], v14 offset:34352
    ds_read_b64_tr_b16 v[132:133], v14 offset:41600
    ds_read_b64_tr_b16 v[134:135], v14 offset:42640
    ds_read_b64_tr_b16 v[136:137], v14 offset:41632
    ds_read_b64_tr_b16 v[138:139], v14 offset:42672
    ds_read_b64_tr_b16 v[140:141], v14 offset:0
    ds_read_b64_tr_b16 v[142:143], v14 offset:1040
    ds_read_b64_tr_b16 v[144:145], v14 offset:32
    ds_read_b64_tr_b16 v[146:147], v14 offset:1072
    ds_read_b64_tr_b16 v[148:149], v14 offset:8320
    ds_read_b64_tr_b16 v[150:151], v14 offset:9360
    ds_read_b64_tr_b16 v[152:153], v14 offset:8352
    s_waitcnt lgkmcnt(8)
    ds_read_b64_tr_b16 v[154:155], v14 offset:9392
    s_setprio 2
    s_barrier
    ds_read_b128 v[220:223], v22
    s_waitcnt lgkmcnt(0)
    v_add_f32 v220, v220, v221
    v_add_f32 v222, v222, v223
    v_add_f32 v220, v220, v222
    v_fma_f32 v220, v220, s34, v20
    v_mul_f32 v220, v220, v24
    v_cvt_pk_bf16_f32 v220, v220, v220
    s_mov_b64 exec, s[8:9]
    ds_write_b16 v23, v220
    s_mov_b64 exec, -1
    s_waitcnt lgkmcnt(0)
    s_setprio 0
    s_barrier
    ds_read_b64_tr_b16 v[156:157], v15 offset:0
    ds_read_b64_tr_b16 v[158:159], v15 offset:1040
    ds_read_b64_tr_b16 v[160:161], v15 offset:32
    ds_read_b64_tr_b16 v[162:163], v15 offset:1072
    ds_read_b64_tr_b16 v[164:165], v16 offset:0
    ds_read_b64_tr_b16 v[166:167], v16 offset:1040
    ds_read_b64_tr_b16 v[168:169], v16 offset:32
    ds_read_b64_tr_b16 v[170:171], v16 offset:1072
    ds_read_b128 v[180:183], v17 offset:0
    ds_read_b128 v[184:187], v17 offset:64
    ds_read_b128 v[188:191], v17 offset:128
    ds_read_b128 v[192:195], v17 offset:192
    ds_read_b128 v[196:199], v17 offset:256
    ds_read_b128 v[200:203], v17 offset:320
    ds_read_b128 v[204:207], v17 offset:384
    s_waitcnt lgkmcnt(8)
    ds_read_b128 v[208:211], v17 offset:448
    s_waitcnt lgkmcnt(0)
    v_mfma_f32_16x16x32_bf16 v[232:235], v[124:127], v[196:199], v[232:235]
    v_mfma_f32_16x16x32_bf16 v[236:239], v[128:131], v[196:199], v[236:239]
    v_mfma_f32_16x16x32_bf16 v[232:235], v[132:135], v[200:203], v[232:235]
    v_mfma_f32_16x16x32_bf16 v[236:239], v[136:139], v[200:203], v[236:239]
    v_mfma_f32_16x16x32_bf16 v[232:235], v[140:143], v[204:207], v[232:235]
    v_mfma_f32_16x16x32_bf16 v[236:239], v[144:147], v[204:207], v[236:239]
    v_mfma_f32_16x16x32_bf16 v[232:235], v[148:151], v[208:211], v[232:235]
    v_mfma_f32_16x16x32_bf16 v[236:239], v[152:155], v[208:211], v[236:239]
    s_branch L_psum_back
.p2align 12
.section .rodata,"a"
.p2align 6
.amdhsa_kernel standalone__sequential_behavior_din__recsys_kernel
.amdhsa_next_free_vgpr 256
.amdhsa_next_free_sgpr 102
.amdhsa_accum_offset 256
.amdhsa_group_segment_fixed_size 0
.amdhsa_kernarg_size 80
.amdhsa_user_sgpr_count 2
.amdhsa_user_sgpr_kernarg_segment_ptr 1
.amdhsa_system_sgpr_workgroup_id_x 1
.end_amdhsa_kernel
```
